```python
import torch

def _softmax(x, axis=-1):
    return torch.softmax(x, dim=axis)
def _gelu(x):
    return torch.nn.functional.gelu(x, approximate="tanh")
def _silu(x):
    return torch.nn.functional.silu(x)
def _sigmoid(x):
    return torch.sigmoid(x)
def _layernorm(x, axis=-1, eps=1e-5):
    m = x.mean(dim=axis, keepdim=True)
    v = x.var(dim=axis, keepdim=True, unbiased=False)
    return (x - m) / torch.sqrt(v + eps)
def _scatter_add(tgt, idx, src, axis=0):
    return tgt.clone().index_add_(axis, idx, src)
def _segment_sum(src, seg, n):
    out = torch.zeros((n,) + src.shape[1:], dtype=src.dtype)
    return out.index_add_(0, seg, src)
def _pad(x, pw):
    flat = tuple(v for pair in reversed(pw) for v in pair)
    return torch.nn.functional.pad(x, flat)

kernel_name = 'interleave_layers__grouped_kv_mqa__dense_activation_silu__prompt'

def setup_inputs():

    _w = (lambda a: (lambda t: t.to(torch.bfloat16) if t.is_floating_point() else t)(torch.as_tensor(a)))
    def _A_setup():
        B, S, D, H = 1, 2048, 512, 32
        Dh = D // H
        return {
            "x": _w((lambda *s: torch.randn(*s, dtype=torch.bfloat16) * 0.05)(B, S, D)),
            "wq": _w((lambda *s: torch.randn(*s, dtype=torch.bfloat16) * 0.05)(D, H * Dh)),
            "wk": _w((lambda *s: torch.randn(*s, dtype=torch.bfloat16) * 0.05)(D, Dh)),
            "wv": _w((lambda *s: torch.randn(*s, dtype=torch.bfloat16) * 0.05)(D, Dh)),
            "wo": _w((lambda *s: torch.randn(*s, dtype=torch.bfloat16) * 0.05)(H * Dh, D)),
        }
    _A_in = _A_setup()

    def _B_setup():
        B, S, D, F = 1, 2048, 512, 1792
        return {
            "x": _w((lambda *s: torch.randn(*s, dtype=torch.bfloat16) * 0.05)(B, S, D)),
            "w1": _w((lambda *s: torch.randn(*s, dtype=torch.bfloat16) * 0.8)(D, F) * (D ** -0.5)),
            "w2": _w((lambda *s: torch.randn(*s, dtype=torch.bfloat16) * 0.8)(F, D) * (F ** -0.5)),
        }
    _B_in = _B_setup()

    return {
        "A_x": _A_in["x"],
        "A_wq": _A_in["wq"],
        "A_wk": _A_in["wk"],
        "A_wv": _A_in["wv"],
        "A_wo": _A_in["wo"],
        "B_x": _B_in["x"],
        "B_w1": _B_in["w1"],
        "B_w2": _B_in["w2"],
    }

def reference(A_x, A_wq, A_wk, A_wv, A_wo, B_x, B_w1, B_w2):
    def _A_ref(x, wq, wk, wv, wo):
        B, S, D = x.shape
        H = 32
        Dh = D // H
        q = (lambda x, *d: x.permute(*d))((x @ wq).reshape(B, S, H, Dh), 0, 2, 1, 3)
        k = x @ wk
        v = x @ wv
        scores = torch.einsum("bhqd,bkd->bhqk", q, k) * (Dh ** -0.5)
        p = _softmax(scores, axis=-1)
        o = torch.einsum("bhqk,bkd->bhqd", p, v)
        return (lambda x, *d: x.permute(*d))(o, 0, 2, 1, 3).reshape(B, S, H * Dh) @ wo

    def _B_ref(x, w1, w2):
        h = torch.einsum("bsd,df->bsf", x, w1)
        h = _silu(h)
        out = torch.einsum("bsf,fd->bsd", h, w2)
        return out

    x = A_x
    x = x + _A_ref(_layernorm(x, axis=-1), A_wq, A_wk, A_wv, A_wo)
    x = x + _B_ref(_layernorm(x, axis=-1), B_w1, B_w2)
    x = x + _A_ref(_layernorm(x, axis=-1), A_wq, A_wk, A_wv, A_wo)
    x = x + _B_ref(_layernorm(x, axis=-1), B_w1, B_w2)
    return x
```

```asm
; @launch grid=(256,1,1) block=(256,1,1) lds=163840
.amdgcn_target "amdgcn-amd-amdhsa--gfx950"
.text
.globl interleave_layers__grouped_kv_mqa__dense_activation_silu__prompt_kernel
.p2align 8
.type interleave_layers__grouped_kv_mqa__dense_activation_silu__prompt_kernel,@function
interleave_layers__grouped_kv_mqa__dense_activation_silu__prompt_kernel:
    s_cmp_ge_u32 s2, 256
    s_cbranch_scc1 L_exit
    s_load_dwordx2 s[4:5], s[0:1], 80
    s_load_dwordx16 s[80:95], s[0:1], 0
    s_load_dwordx2 s[42:43], s[0:1], 64
    v_lshrrev_b32 v3, 6, v0
    v_and_b32 v1, 63, v0
    v_readfirstlane_b32 s22, v3
    s_getpc_b64 s[96:97]
L_pc:
    s_lshr_b32 s98, s2, 3
    s_lshl_b32 s98, s98, 2
    s_and_b32 s98, s98, 31
    v_add_u32 v3, s98, v3
    v_and_b32 v7, 15, v0
    v_lshl_add_u32 v3, v3, 4, v7
    v_lshlrev_b32 v3, 7, v3
    v_min_u32 v3, L_end-L_pc-4, v3
    global_load_dword v27, v3, s[96:97]
    v_lshlrev_b32 v0, 4, v1
    s_mov_b32 s6, 0x10000000
    s_mov_b32 s7, 0x20000
    s_mov_b32 s11, 0x20000
    s_mov_b32 s15, 0x20000
    s_mov_b32 s19, 0x20000
    s_mov_b32 s47, 0x20000
    s_mov_b32 s10, 524288
    s_mov_b32 s14, 16384
    s_mov_b32 s18, 2097152
    s_and_b32 s96, s2, 7
    s_lshr_b32 s97, s2, 3
    s_and_b32 s21, s97, 7
    s_lshr_b32 s97, s97, 3
    s_lshl_b32 s96, s96, 2
    s_add_u32 s20, s96, s97
    s_and_b32 s26, s22, 1
    s_lshr_b32 s27, s22, 1
    v_and_b32 v3, 31, v1
    v_lshrrev_b32 v7, 5, v1
    s_lshl_b32 s96, s20, 16
    v_lshrrev_b32 v65, 3, v1
    v_and_b32 v74, 7, v1
    v_and_b32 v76, 16, v1
    v_lshlrev_b32 v74, 4, v74
    v_lshlrev_b32 v76, 2, v76
    v_xor_b32 v74, v74, v76
    v_lshl_add_u32 v43, v65, 10, v74
    s_lshl_b32 s74, s22, 17
    s_lshl_b32 s99, s21, 7
    s_add_u32 s74, s74, s99
    v_and_b32 v84, 15, v1
    v_lshrrev_b32 v85, 4, v1
    v_xor_b32 v88, v84, v85
    v_lshlrev_b32 v88, 4, v88
    v_lshl_add_u32 v88, v85, 10, v88
    v_xor_b32 v89, 64, v88
    v_add_u32 v89, 3072, v89
    v_xor_b32 v90, 128, v88
    v_add_u32 v90, 6144, v90
    v_xor_b32 v91, 192, v88
    v_add_u32 v91, 9216, v91
    v_lshlrev_b32 v92, 7, v84
    s_waitcnt lgkmcnt(0)
    s_load_dword s23, s[4:5], 0
    s_mov_b32 s16, s80
    s_mov_b32 s17, s81
    s_mov_b32 s8, s82
    s_mov_b32 s9, s83
    s_bitcmp1_b32 s21, 0
    s_cselect_b32 s12, s86, s84
    s_cselect_b32 s13, s87, s85
    s_lshl_b32 s97, s21, 2
    s_add_u32 s97, s97, s22
    s_lshl_b32 s97, s97, 11
    s_add_u32 s97, s97, s96
    buffer_load_dword v27, v92, s[16:19], s97 offen
    s_and_b32 s97, s20, 3
    s_lshl_b32 s97, s97, 15
    s_add_u32 s97, s97, s74
    v_lshlrev_b32 v76, 10, v3
    buffer_load_dword v27, v76, s[8:11], s97 offen
    s_lshl_b32 s97, s22, 12
    s_add_u32 m0, s97, 147456
    s_nop 0
    buffer_load_dwordx4 v0, s[12:15], s97 offen offset:0 lds
    buffer_load_dwordx4 v0, s[12:15], s97 offen offset:1024 lds
    buffer_load_dwordx4 v0, s[12:15], s97 offen offset:2048 lds
    buffer_load_dwordx4 v0, s[12:15], s97 offen offset:3072 lds
    s_lshl_b32 s98, s22, 8
    s_add_u32 s91, s96, s98
    s_lshl_b32 m0, s22, 14
    s_nop 0
    buffer_load_dwordx4 v88, s[16:19], s91 offen offset:0 lds
    buffer_load_dwordx4 v89, s[16:19], s91 offen offset:1024 lds
    buffer_load_dwordx4 v90, s[16:19], s91 offen offset:2048 lds
    buffer_load_dwordx4 v91, s[16:19], s91 offen offset:3072 lds
    s_add_u32 m0, m0, 4096
    s_add_u32 s91, s91, 16384
    buffer_load_dwordx4 v88, s[16:19], s91 offen offset:0 lds
    buffer_load_dwordx4 v89, s[16:19], s91 offen offset:1024 lds
    buffer_load_dwordx4 v90, s[16:19], s91 offen offset:2048 lds
    buffer_load_dwordx4 v91, s[16:19], s91 offen offset:3072 lds
    s_add_u32 m0, m0, 4096
    s_add_u32 s91, s91, 16384
    s_lshr_b32 s99, s21, 2
    s_lshl_b32 s99, s99, 1
    s_cmp_eq_u32 s99, s22
    s_cselect_b32 s48, 1, 0
    s_lshl_b32 s97, s2, 2
    s_add_u32 s97, s97, s22
    s_lshr_b32 s98, s97, 1
    s_cmp_ge_u32 s97, 448
    s_cbranch_scc1 L_job_n
    s_mov_b32 s46, 1835008
    s_lshr_b32 s99, s98, 3
    s_lshl_b32 s99, s99, 1
    s_add_u32 s99, s99, s26
    s_and_b32 s98, s98, 7
    s_mul_i32 s100, s99, 33792
    s_add_u32 s100, s100, 589824
    s_lshr_b32 s101, s98, 2
    s_lshl_b32 s101, s101, 9
    s_and_b32 s3, s98, 3
    s_lshl_b32 s3, s3, 2
    s_add_u32 s101, s101, s3
    s_add_u32 s101, s101, s100
    s_add_u32 s101, s101, 32768
    s_movk_i32 s3, 3584
    s_branch L_job_go
L_job_n:
    s_cmp_ge_u32 s97, 896
    s_mov_b32 s99, 1835008
    s_cselect_b32 s46, 524288, s99
    s_movk_i32 s99, 224
    s_cselect_b32 s99, 448, s99
    s_sub_u32 s98, s98, s99
    s_cmp_ge_u32 s97, 896
    s_mov_b32 s101, 114688
    s_cselect_b32 s101, 32768, s101
    s_mov_b32 s100, 2490368
    s_cselect_b32 s100, 65536, s100
    s_and_b32 s99, s98, 7
    s_lshl_b32 s99, s99, 1
    s_add_u32 s99, s99, s26
    s_lshr_b32 s98, s98, 3
    s_mul_i32 s101, s101, s99
    s_add_u32 s100, s100, s101
    s_mov_b32 s101, 536870912
    s_movk_i32 s3, 1024
L_job_go:
    s_lshl_b32 s97, s98, 12
    s_add_u32 s100, s100, s97
    s_lshl_b32 s98, s98, 1
    s_add_u32 s98, s98, s26
    s_mul_i32 s97, s98, s3
    s_lshl_b32 s97, s97, 5
    s_lshr_b32 s99, s99, 1
    s_lshl_b32 s99, s99, 7
    s_add_u32 s36, s97, s99
    v_mul_lo_u32 v75, s3, v65
    v_add_u32 v75, v75, v74
    s_lshl_b32 s37, s3, 3
    s_lshl_b32 s78, s20, 5
    s_lshl_b32 s97, s21, 2
    s_add_u32 s78, s78, s97
    s_mov_b32 s28, 0x40000
    s_mov_b32 s29, 0x3f803f80
    s_mov_b32 s24, 0
    s_mov_b32 s25, 0
    s_sub_u32 s32, 0, s27
    s_mov_b32 s33, s32
    s_mul_i32 s31, s20, 1792
    s_add_u32 s31, s31, 9306112
    s_lshl_b32 s97, s21, 4
    s_lshl_b32 s98, s22, 2
    s_add_u32 s30, s31, s97
    s_add_u32 s30, s30, s98
    s_lshl_b32 s97, s22, 3
    s_lshl_b32 s34, 0xff, s97
    s_lshl_b32 s97, s21, 2
    s_lshl_b32 s97, 15, s97
    s_or_b32 s34, s34, s97
    s_mov_b32 s35, 0
    s_lshl_b32 s97, s27, 15
    s_add_u32 s97, s97, s96
    s_add_u32 s97, s97, 4325376
    s_lshl_b32 s98, s21, 12
    s_lshl_b32 s99, s26, 11
    s_add_u32 s98, s98, s99
    s_add_u32 s49, s97, s98
    s_lshl_b32 s98, s22, 13
    s_add_u32 s52, s97, s98
    s_xor_b32 s51, s52, 0x8000
    s_lshr_b32 s97, s96, 3
    s_add_u32 s97, s97, 8519680
    s_lshl_b32 s98, s27, 9
    s_add_u32 s79, s97, s98
    s_lshl_b32 s98, s21, 10
    s_lshl_b32 s99, s26, 3
    s_add_u32 s98, s98, s99
    s_add_u32 s50, s79, s98
    s_lshr_b32 s97, s20, 2
    s_lshl_b32 s98, s97, 14
    s_lshl_b32 s99, s22, 12
    s_add_u32 s98, s98, s99
    s_add_u32 s54, s98, 8781824
    s_mov_b32 s56, 8192
    s_lshr_b32 s97, s20, 1
    s_lshl_b32 s97, s97, 13
    s_and_b32 s98, s20, 1
    s_lshl_b32 s98, s98, 11
    s_add_u32 s97, s97, s98
    s_lshr_b32 s98, s21, 2
    s_lshl_b32 s98, s98, 10
    s_add_u32 s97, s97, s98
    s_add_u32 s77, s97, 8781824
    s_lshl_b32 s97, s21, 1
    s_add_u32 s97, s97, s26
    s_xor_b32 s98, s97, 1
    s_lshl_b32 s99, s22, 13
    s_add_u32 s99, s99, 65536
    s_lshl_b32 s57, s98, 15
    s_add_u32 s57, s57, s99
    s_lshl_b32 s58, s97, 15
    s_add_u32 s58, s58, s99
    s_mul_i32 s99, s22, 28672
    s_add_u32 s99, s99, 2490368
    s_mul_i32 s69, s98, 114688
    s_add_u32 s69, s69, s99
    s_mul_i32 s70, s97, 114688
    s_add_u32 s70, s70, s99
    s_mul_i32 s97, s21, 7
    s_add_u32 s97, s97, s22
    s_mul_i32 s59, s97, 33792
    s_add_u32 s59, s59, 589824
    s_add_u32 s64, s59, 135168
    s_mul_i32 s98, s20, 229376
    s_add_u32 s98, s98, 9437184
    s_lshl_b32 s97, s97, 11
    s_add_u32 s71, s98, s97
    s_add_u32 s72, s71, 8192
    s_mul_i32 s97, s22, 28672
    s_add_u32 s73, s98, s97
    s_cmp_eq_u32 s22, 3
    s_cselect_b32 s64, 536870912, s64
    s_cselect_b32 s72, 536870912, s72
    s_add_u32 s60, s59, 8192
    s_add_u32 s61, s60, 8192
    s_add_u32 s62, s61, 8192
    s_add_u32 s63, s62, 8192
    s_add_u32 s65, s64, 8192
    s_add_u32 s66, s65, 8192
    s_add_u32 s67, s66, 8192
    s_add_u32 s68, s67, 8192
    v_lshlrev_b32 v2, 2, v3
    v_lshlrev_b32 v4, 4, v3
    v_lshl_add_u32 v4, v7, 2, v4
    v_add_u32 v5, 4096, v0
    s_mul_i32 s97, s22, 12288
    s_add_u32 s97, s97, 16384
    v_add_u32 v6, s97, v0
    s_xor_b32 s97, s22, 1
    s_mul_i32 s97, s97, 12288
    s_add_u32 s97, s97, 16384
    v_add_u32 v40, s97, v0
    s_xor_b32 s97, s22, 2
    s_mul_i32 s97, s97, 12288
    s_add_u32 s97, s97, 20480
    v_add_u32 v41, s97, v0
    s_xor_b32 s97, s22, 3
    s_mul_i32 s97, s97, 12288
    s_add_u32 s97, s97, 24576
    v_add_u32 v42, s97, v0
    v_and_b32 v76, 12, v1
    v_lshlrev_b32 v76, 5, v76
    v_and_b32 v77, 8, v1
    v_lshl_add_u32 v76, v77, 3, v76
    v_and_b32 v77, 16, v1
    v_lshl_add_u32 v76, v77, 1, v76
    v_and_b32 v77, 3, v1
    v_lshl_add_u32 v76, v77, 3, v76
    s_lshl_b32 s97, s26, 6
    v_xor_b32 v76, s97, v76
    s_lshl_b32 s97, s22, 14
    s_add_u32 s97, s97, 73728
    v_lshl_add_u32 v39, v7, 10, v76
    v_add_u32 v39, s97, v39
    s_cmp_eq_u32 s101, 536870912
    s_cselect_b32 s97, 9, 10
    s_cselect_b32 s98, 512, 0
    s_add_u32 s98, s98, 512
    v_lshlrev_b32 v77, s97, v7
    v_add_u32 v76, v76, v77
    s_lshl_b32 s97, s27, 15
    s_add_u32 s97, s97, 73728
    v_add_u32 v24, s97, v76
    v_add_u32 v25, s98, v24
    v_lshlrev_b32 v38, 7, v1
    v_add_u32 v38, s31, v38
    s_and_b32 s97, s78, -128
    s_add_u32 s97, s97, 10240
    v_and_b32 v76, 1, v1
    v_lshl_add_u32 v76, v76, 10, s97
    v_cmp_gt_u32 vcc, 14, v1
    s_nop 1
    v_cndmask_b32 v38, v76, v38, vcc
    s_and_b32 s98, s21, 2
    s_lshl_b32 s98, s98, 7
    s_add_u32 s97, s77, 262144
    s_add_u32 s97, s97, s98
    s_add_u32 s98, s98, 4096
    s_bitcmp1_b32 s21, 0
    s_cselect_b32 s98, s98, 0
    s_cselect_b32 s99, 7, 8
    s_add_u32 s97, s97, s98
    v_and_b32 v76, 1, v1
    v_lshl_add_u32 v76, v76, 7, s97
    v_and_b32 v77, 2, v1
    v_lshlrev_b32 v77, s99, v77
    v_add_u32 v76, v76, v77
    v_and_b32 v77, 4, v1
    v_lshl_add_u32 v76, v77, 15, v76
    v_cmp_gt_u32 vcc, 16, v1
    s_nop 1
    v_cndmask_b32 v38, v76, v38, vcc
    s_and_b32 s97, s50, -1024
    v_and_b32 v76, 7, v1
    v_lshl_add_u32 v76, v76, 7, s97
    v_cmp_gt_u32 vcc, 32, v1
    s_nop 1
    v_cndmask_b32 v38, v76, v38, vcc
    v_and_b32 v76, 11, v1
    v_cmp_eq_u32 vcc, 0, v76
    v_mov_b32 v77, s29
    s_nop 0
    v_cndmask_b32 v80, 0, v77, vcc
    v_cndmask_b32 v81, 0, v77, vcc
    v_cndmask_b32 v82, 0, v77, vcc
    v_cndmask_b32 v83, 0, v77, vcc
    s_lshl_b32 s97, s22, 10
    s_add_u32 s97, s97, 139264
    v_add_u32 v76, s97, v0
    ds_write_b128 v76, v[80:83]
    buffer_load_dwordx4 v88, s[16:19], s91 offen offset:0 lds
    buffer_load_dwordx4 v89, s[16:19], s91 offen offset:1024 lds
    buffer_load_dwordx4 v90, s[16:19], s91 offen offset:2048 lds
    buffer_load_dwordx4 v91, s[16:19], s91 offen offset:3072 lds
    s_add_u32 m0, m0, 4096
    s_add_u32 s91, s91, 16384
    buffer_load_dwordx4 v88, s[16:19], s91 offen offset:0 lds
    buffer_load_dwordx4 v89, s[16:19], s91 offen offset:1024 lds
    buffer_load_dwordx4 v90, s[16:19], s91 offen offset:2048 lds
    buffer_load_dwordx4 v91, s[16:19], s91 offen offset:3072 lds
    s_lshl_b32 s91, s22, 14
    s_add_u32 m0, s91, 73728
    s_mov_b32 s90, s74
    buffer_load_dwordx4 v43, s[8:11], s90 offen offset:0 lds
    s_add_u32 s90, s90, 7168
    buffer_load_dwordx4 v43, s[8:11], s90 offen offset:1024 lds
    s_add_u32 s90, s90, 7168
    buffer_load_dwordx4 v43, s[8:11], s90 offen offset:2048 lds
    s_add_u32 s90, s90, 7168
    buffer_load_dwordx4 v43, s[8:11], s90 offen offset:3072 lds
    s_waitcnt lgkmcnt(0)
    s_and_b32 s23, s23, -8
    s_add_u32 s23, s23, 8
    s_getreg_b32 s97, hwreg(HW_REG_XCC_ID)
    s_and_b32 s97, s97, 7
    s_mov_b32 s55, s97
    s_or_b32 s97, s97, s23
    v_mov_b32 v36, s97
    s_cmp_lg_u32 s22, 1
    s_cbranch_scc1 L_pdone
    s_add_u32 s97, s78, 4096
    s_mov_b64 exec, 1
    buffer_store_dword v36, off, s[4:7], s97 offset:0 sc1
    s_mov_b64 exec, -1
L_pdone:
    v_xor_b32 v76, v84, v7
    v_lshlrev_b32 v76, 4, v76
    v_lshl_add_u32 v76, v3, 8, v76
    s_lshl_b32 s97, s22, 14
    v_add_u32 v96, s97, v76
    v_xor_b32 v97, 32, v96
    v_xor_b32 v98, 64, v96
    v_xor_b32 v99, 96, v96
    v_xor_b32 v100, 128, v96
    v_xor_b32 v101, 160, v96
    v_xor_b32 v102, 192, v96
    v_xor_b32 v103, 224, v96
    v_lshlrev_b32 v76, 4, v84
    v_lshl_add_u32 v76, v3, 8, v76
    v_lshl_add_u32 v76, v7, 3, v76
    s_and_b32 s97, s21, 1
    s_lshl_b32 s97, s97, 1
    s_add_u32 s97, s97, s26
    s_lshl_b32 s97, s97, 6
    v_xor_b32 v76, s97, v76
    s_lshr_b32 s97, s21, 1
    s_lshl_b32 s98, s97, 14
    s_lshl_b32 s99, s27, 13
    s_add_u32 s98, s98, s99
    v_add_u32 v76, s98, v76
    v_xor_b32 v77, 16, v76
    v_xor_b32 v78, 32, v76
    v_xor_b32 v79, 48, v76
    v_xor_b32 v80, v84, v85
    v_lshlrev_b32 v80, 4, v80
    v_lshl_add_u32 v80, v84, 8, v80
    s_lshl_b32 s97, s97, 12
    s_lshl_b32 s98, s22, 14
    s_add_u32 s97, s97, s98
    v_add_u32 v80, s97, v80
    v_xor_b32 v81, 64, v80
    v_xor_b32 v82, 128, v80
    v_xor_b32 v83, 192, v80
    v_lshlrev_b32 v86, 3, v84
    v_lshl_add_u32 v86, v85, 8, v86
    v_add_u32 v86, 147456, v86
    s_lshl_b32 s97, s22, 12
    v_add_u32 v87, s97, v86
    s_waitcnt vmcnt(4)
    s_barrier
    s_cmp_eq_u32 s27, 0
    s_cbranch_scc1 L_f0c
    ds_read_b128 v[108:111], v96 offset:0
    ds_read_b128 v[112:115], v97 offset:0
    ds_read_b128 v[116:119], v98 offset:0
    ds_read_b128 v[120:123], v99 offset:0
    ds_read_b128 v[124:127], v100 offset:0
    ds_read_b128 v[128:131], v101 offset:0
    ds_read_b128 v[132:135], v102 offset:0
    ds_read_b128 v[136:139], v103 offset:0
    ds_read_b128 v[140:143], v96 offset:8192
    ds_read_b128 v[144:147], v97 offset:8192
    ds_read_b128 v[148:151], v98 offset:8192
    ds_read_b128 v[152:155], v99 offset:8192
    s_waitcnt lgkmcnt(8)
    ds_read_b128 v[156:159], v100 offset:8192
    ds_read_b128 v[160:163], v101 offset:8192
    ds_read_b128 v[164:167], v102 offset:8192
    ds_read_b128 v[168:171], v103 offset:8192
    s_branch L_f0d
L_f0c:
    ds_read_b128 v[108:111], v96 offset:8192
    ds_read_b128 v[112:115], v97 offset:8192
    ds_read_b128 v[116:119], v98 offset:8192
    ds_read_b128 v[120:123], v99 offset:8192
    ds_read_b128 v[124:127], v100 offset:8192
    ds_read_b128 v[128:131], v101 offset:8192
    ds_read_b128 v[132:135], v102 offset:8192
    ds_read_b128 v[136:139], v103 offset:8192
    ds_read_b128 v[140:143], v96 offset:0
    ds_read_b128 v[144:147], v97 offset:0
    ds_read_b128 v[148:151], v98 offset:0
    ds_read_b128 v[152:155], v99 offset:0
    s_waitcnt lgkmcnt(8)
    ds_read_b128 v[156:159], v100 offset:0
    ds_read_b128 v[160:163], v101 offset:0
    ds_read_b128 v[164:167], v102 offset:0
    ds_read_b128 v[168:171], v103 offset:0
L_f0d:
    s_add_u32 m0, m0, 4096
    s_add_u32 s90, s90, 11264
    buffer_load_dwordx4 v43, s[8:11], s90 offen offset:0 lds
    v_dot2_f32_bf16 v44, v108, s29, 0
    v_dot2_f32_bf16 v45, v108, v108, 0
    v_dot2_f32_bf16 v44, v109, s29, v44
    v_dot2_f32_bf16 v45, v109, v109, v45
    v_dot2_f32_bf16 v44, v110, s29, v44
    v_dot2_f32_bf16 v45, v110, v110, v45
    v_dot2_f32_bf16 v44, v111, s29, v44
    v_dot2_f32_bf16 v45, v111, v111, v45
    s_add_u32 s90, s90, 7168
    buffer_load_dwordx4 v43, s[8:11], s90 offen offset:1024 lds
    v_dot2_f32_bf16 v44, v112, s29, v44
    v_dot2_f32_bf16 v45, v112, v112, v45
    v_dot2_f32_bf16 v44, v113, s29, v44
    v_dot2_f32_bf16 v45, v113, v113, v45
    v_dot2_f32_bf16 v44, v114, s29, v44
    v_dot2_f32_bf16 v45, v114, v114, v45
    v_dot2_f32_bf16 v44, v115, s29, v44
    v_dot2_f32_bf16 v45, v115, v115, v45
    s_add_u32 s90, s90, 7168
    buffer_load_dwordx4 v43, s[8:11], s90 offen offset:2048 lds
    v_dot2_f32_bf16 v44, v116, s29, v44
    v_dot2_f32_bf16 v45, v116, v116, v45
    v_dot2_f32_bf16 v44, v117, s29, v44
    v_dot2_f32_bf16 v45, v117, v117, v45
    v_dot2_f32_bf16 v44, v118, s29, v44
    v_dot2_f32_bf16 v45, v118, v118, v45
    v_dot2_f32_bf16 v44, v119, s29, v44
    v_dot2_f32_bf16 v45, v119, v119, v45
    s_add_u32 s90, s90, 7168
    buffer_load_dwordx4 v43, s[8:11], s90 offen offset:3072 lds
    v_dot2_f32_bf16 v44, v120, s29, v44
    v_dot2_f32_bf16 v45, v120, v120, v45
    v_dot2_f32_bf16 v44, v121, s29, v44
    v_dot2_f32_bf16 v45, v121, v121, v45
    v_dot2_f32_bf16 v44, v122, s29, v44
    v_dot2_f32_bf16 v45, v122, v122, v45
    v_dot2_f32_bf16 v44, v123, s29, v44
    v_dot2_f32_bf16 v45, v123, v123, v45
    s_waitcnt lgkmcnt(8)
    s_add_u32 m0, m0, 4096
    s_add_u32 s90, s90, 11264
    buffer_load_dwordx4 v43, s[8:11], s90 offen offset:0 lds
    v_dot2_f32_bf16 v44, v124, s29, v44
    v_dot2_f32_bf16 v45, v124, v124, v45
    v_dot2_f32_bf16 v44, v125, s29, v44
    v_dot2_f32_bf16 v45, v125, v125, v45
    v_dot2_f32_bf16 v44, v126, s29, v44
    v_dot2_f32_bf16 v45, v126, v126, v45
    v_dot2_f32_bf16 v44, v127, s29, v44
    v_dot2_f32_bf16 v45, v127, v127, v45
    s_add_u32 s90, s90, 7168
    buffer_load_dwordx4 v43, s[8:11], s90 offen offset:1024 lds
    v_dot2_f32_bf16 v44, v128, s29, v44
    v_dot2_f32_bf16 v45, v128, v128, v45
    v_dot2_f32_bf16 v44, v129, s29, v44
    v_dot2_f32_bf16 v45, v129, v129, v45
    v_dot2_f32_bf16 v44, v130, s29, v44
    v_dot2_f32_bf16 v45, v130, v130, v45
    v_dot2_f32_bf16 v44, v131, s29, v44
    v_dot2_f32_bf16 v45, v131, v131, v45
    s_add_u32 s90, s90, 7168
    buffer_load_dwordx4 v43, s[8:11], s90 offen offset:2048 lds
    v_dot2_f32_bf16 v44, v132, s29, v44
    v_dot2_f32_bf16 v45, v132, v132, v45
    v_dot2_f32_bf16 v44, v133, s29, v44
    v_dot2_f32_bf16 v45, v133, v133, v45
    v_dot2_f32_bf16 v44, v134, s29, v44
    v_dot2_f32_bf16 v45, v134, v134, v45
    v_dot2_f32_bf16 v44, v135, s29, v44
    v_dot2_f32_bf16 v45, v135, v135, v45
    s_add_u32 s90, s90, 7168
    buffer_load_dwordx4 v43, s[8:11], s90 offen offset:3072 lds
    v_dot2_f32_bf16 v44, v136, s29, v44
    v_dot2_f32_bf16 v45, v136, v136, v45
    v_dot2_f32_bf16 v44, v137, s29, v44
    v_dot2_f32_bf16 v45, v137, v137, v45
    v_dot2_f32_bf16 v44, v138, s29, v44
    v_dot2_f32_bf16 v45, v138, v138, v45
    v_dot2_f32_bf16 v44, v139, s29, v44
    v_dot2_f32_bf16 v45, v139, v139, v45
    s_waitcnt lgkmcnt(4)
    ds_read_b64 v[66:67], v76
    ds_read_b64 v[68:69], v77
    ds_read_b64 v[70:71], v78
    ds_read_b64 v[72:73], v79
    s_add_u32 m0, m0, 4096
    s_add_u32 s90, s90, 11264
    buffer_load_dwordx4 v43, s[8:11], s90 offen offset:0 lds
    v_dot2_f32_bf16 v46, v140, s29, 0
    v_dot2_f32_bf16 v47, v140, v140, 0
    v_dot2_f32_bf16 v46, v141, s29, v46
    v_dot2_f32_bf16 v47, v141, v141, v47
    v_dot2_f32_bf16 v46, v142, s29, v46
    v_dot2_f32_bf16 v47, v142, v142, v47
    v_dot2_f32_bf16 v46, v143, s29, v46
    v_dot2_f32_bf16 v47, v143, v143, v47
    s_add_u32 s90, s90, 7168
    buffer_load_dwordx4 v43, s[8:11], s90 offen offset:1024 lds
    v_dot2_f32_bf16 v46, v144, s29, v46
    v_dot2_f32_bf16 v47, v144, v144, v47
    v_dot2_f32_bf16 v46, v145, s29, v46
    v_dot2_f32_bf16 v47, v145, v145, v47
    v_dot2_f32_bf16 v46, v146, s29, v46
    v_dot2_f32_bf16 v47, v146, v146, v47
    v_dot2_f32_bf16 v46, v147, s29, v46
    v_dot2_f32_bf16 v47, v147, v147, v47
    s_add_u32 s90, s90, 7168
    buffer_load_dwordx4 v43, s[8:11], s90 offen offset:2048 lds
    v_dot2_f32_bf16 v46, v148, s29, v46
    v_dot2_f32_bf16 v47, v148, v148, v47
    v_dot2_f32_bf16 v46, v149, s29, v46
    v_dot2_f32_bf16 v47, v149, v149, v47
    v_dot2_f32_bf16 v46, v150, s29, v46
    v_dot2_f32_bf16 v47, v150, v150, v47
    v_dot2_f32_bf16 v46, v151, s29, v46
    v_dot2_f32_bf16 v47, v151, v151, v47
    s_add_u32 s90, s90, 7168
    buffer_load_dwordx4 v43, s[8:11], s90 offen offset:3072 lds
    v_dot2_f32_bf16 v46, v152, s29, v46
    v_dot2_f32_bf16 v47, v152, v152, v47
    v_dot2_f32_bf16 v46, v153, s29, v46
    v_dot2_f32_bf16 v47, v153, v153, v47
    v_dot2_f32_bf16 v46, v154, s29, v46
    v_dot2_f32_bf16 v47, v154, v154, v47
    v_dot2_f32_bf16 v46, v155, s29, v46
    v_dot2_f32_bf16 v47, v155, v155, v47
    s_waitcnt lgkmcnt(4)
    v_dot2_f32_bf16 v46, v156, s29, v46
    v_dot2_f32_bf16 v47, v156, v156, v47
    v_dot2_f32_bf16 v46, v157, s29, v46
    v_dot2_f32_bf16 v47, v157, v157, v47
    v_dot2_f32_bf16 v46, v158, s29, v46
    v_dot2_f32_bf16 v47, v158, v158, v47
    v_dot2_f32_bf16 v46, v159, s29, v46
    v_dot2_f32_bf16 v47, v159, v159, v47
    v_dot2_f32_bf16 v46, v160, s29, v46
    v_dot2_f32_bf16 v47, v160, v160, v47
    v_dot2_f32_bf16 v46, v161, s29, v46
    v_dot2_f32_bf16 v47, v161, v161, v47
    v_dot2_f32_bf16 v46, v162, s29, v46
    v_dot2_f32_bf16 v47, v162, v162, v47
    v_dot2_f32_bf16 v46, v163, s29, v46
    v_dot2_f32_bf16 v47, v163, v163, v47
    v_dot2_f32_bf16 v46, v164, s29, v46
    v_dot2_f32_bf16 v47, v164, v164, v47
    v_dot2_f32_bf16 v46, v165, s29, v46
    v_dot2_f32_bf16 v47, v165, v165, v47
    v_dot2_f32_bf16 v46, v166, s29, v46
    v_dot2_f32_bf16 v47, v166, v166, v47
    v_dot2_f32_bf16 v46, v167, s29, v46
    v_dot2_f32_bf16 v47, v167, v167, v47
    v_dot2_f32_bf16 v46, v168, s29, v46
    v_dot2_f32_bf16 v47, v168, v168, v47
    v_dot2_f32_bf16 v46, v169, s29, v46
    v_dot2_f32_bf16 v47, v169, v169, v47
    v_dot2_f32_bf16 v46, v170, s29, v46
    v_dot2_f32_bf16 v47, v170, v170, v47
    v_dot2_f32_bf16 v46, v171, s29, v46
    v_dot2_f32_bf16 v47, v171, v171, v47
    v_permlane32_swap_b32 v44, v45
    s_nop 1
    v_permlane32_swap_b32 v46, v47
    s_lshl_b32 s97, s27, 10
    s_add_u32 s97, s97, 65536
    v_lshl_add_u32 v48, v2, 3, s97
    s_lshl_b32 s97, s22, 3
    v_lshl_add_u32 v49, v7, 2, v48
    v_add_u32 v49, s97, v49
    v_xor_b32 v50, 1024, v49
    v_add_f32 v44, v44, v45
    v_add_f32 v46, v46, v47
    ds_write_b32 v50, v44
    ds_write_b32 v49, v46
    s_cmp_ge_u32 s2, 224
    s_cselect_b32 s44, s88, s94
    s_cselect_b32 s45, s89, s95
    s_cmp_lt_u32 s2, 112
    s_cselect_b32 s44, s92, s44
    s_cselect_b32 s45, s93, s45
    buffer_load_dwordx4 v[172:175], v75, s[44:47], s36 offen
    s_add_u32 s36, s36, s37
    buffer_load_dwordx4 v[176:179], v75, s[44:47], s36 offen
    s_add_u32 s36, s36, s37
    buffer_load_dwordx4 v[244:247], v75, s[44:47], s36 offen
    s_add_u32 s36, s36, s37
    buffer_load_dwordx4 v[248:251], v75, s[44:47], s36 offen
    buffer_load_dword v27, v38, s[4:7], 0 offen sc1
    s_waitcnt vmcnt(37)
    ds_read_b128 a[16:19], v80
    ds_read_b64_tr_b16 v[180:181], v87 offset:0
    ds_read_b64_tr_b16 v[182:183], v87 offset:128
    ds_read_b128 a[20:23], v81
    ds_read_b64_tr_b16 v[184:185], v87 offset:1024
    ds_read_b64_tr_b16 v[186:187], v87 offset:1152
    ds_read_b128 a[24:27], v82
    ds_read_b64_tr_b16 v[188:189], v87 offset:2048
    ds_read_b64_tr_b16 v[190:191], v87 offset:2176
    ds_read_b128 a[28:31], v83
    ds_read_b64_tr_b16 v[192:193], v87 offset:3072
    ds_read_b64_tr_b16 v[194:195], v87 offset:3200
    s_lshl_b32 s97, s22, 2
    s_add_u32 s97, s97, 146432
    v_add_u32 v54, s97, v0
    s_waitcnt lgkmcnt(0)
    s_lshl_b32 s97, s22, 10
    s_add_u32 s97, s97, 69632
    v_add_u32 v64, s97, v0
    s_bitcmp1_b32 s21, 0
    s_cbranch_scc1 L_kp_1
    v_mfma_f32_16x16x32_bf16 v[60:63], v[180:183], a[16:19], 0
    v_mfma_f32_16x16x32_bf16 v[60:63], v[184:187], a[20:23], v[60:63]
    v_mfma_f32_16x16x32_bf16 v[60:63], v[188:191], a[24:27], v[60:63]
    v_mfma_f32_16x16x32_bf16 v[60:63], v[192:195], a[28:31], v[60:63]
    s_branch L_kq_2
L_kp_1:
    v_mfma_f32_16x16x32_bf16 v[60:63], a[16:19], v[180:183], 0
    v_mfma_f32_16x16x32_bf16 v[60:63], a[20:23], v[184:187], v[60:63]
    v_mfma_f32_16x16x32_bf16 v[60:63], a[24:27], v[188:191], v[60:63]
    v_mfma_f32_16x16x32_bf16 v[60:63], a[28:31], v[192:195], v[60:63]
L_kq_2:
    v_dot2_f32_bf16 v52, v180, s29, 0
    v_dot2_f32_bf16 v53, v181, s29, 0
    v_dot2_f32_bf16 v52, v182, s29, v52
    v_dot2_f32_bf16 v53, v183, s29, v53
    v_dot2_f32_bf16 v52, v184, s29, v52
    v_dot2_f32_bf16 v53, v185, s29, v53
    v_dot2_f32_bf16 v52, v186, s29, v52
    v_dot2_f32_bf16 v53, v187, s29, v53
    v_dot2_f32_bf16 v52, v188, s29, v52
    v_dot2_f32_bf16 v53, v189, s29, v53
    v_dot2_f32_bf16 v52, v190, s29, v52
    v_dot2_f32_bf16 v53, v191, s29, v53
    v_dot2_f32_bf16 v52, v192, s29, v52
    v_dot2_f32_bf16 v53, v193, s29, v53
    v_dot2_f32_bf16 v52, v194, s29, v52
    v_dot2_f32_bf16 v53, v195, s29, v53
    ds_write_b128 v64, v[60:63]
    s_nop 1
    v_add_f32 v52, v52, v53
    v_cvt_pk_bf16_f32 v53, v52, v52
    v_lshlrev_b32 v53, 16, v53
    v_sub_f32 v53, v52, v53
    v_cvt_pk_bf16_f32 v55, v52, v53
    ds_write_b32 v54, v55
    s_waitcnt lgkmcnt(0)
    s_barrier
    ds_read_b128 v[56:59], v48
    ds_read_b128 v[60:63], v48 offset:16
    s_waitcnt lgkmcnt(0)
    v_pk_add_f32 v[56:57], v[56:57], v[58:59]
    v_pk_add_f32 v[60:61], v[60:61], v[62:63]
    v_pk_add_f32 v[56:57], v[56:57], v[60:61]
    v_mul_f32 v56, 0x3b000000, v56
    v_mul_f32 v57, 0x3b000000, v57
    v_fma_f32 v57, -v56, v56, v57
    v_max_f32 v57, 0, v57
    v_add_f32 v57, 0x3727c5ac, v57
    v_rsq_f32 v26, v57
    v_cvt_pk_bf16_f32 v28, -v56, -v56
    v_lshlrev_b32 v8, 16, v66
    v_and_b32 v9, 0xffff0000, v66
    v_lshlrev_b32 v10, 16, v67
    v_and_b32 v11, 0xffff0000, v67
    v_lshlrev_b32 v12, 16, v68
    v_and_b32 v13, 0xffff0000, v68
    v_lshlrev_b32 v14, 16, v69
    v_and_b32 v15, 0xffff0000, v69
    v_lshlrev_b32 v16, 16, v70
    v_and_b32 v17, 0xffff0000, v70
    v_lshlrev_b32 v18, 16, v71
    v_and_b32 v19, 0xffff0000, v71
    v_lshlrev_b32 v20, 16, v72
    v_and_b32 v21, 0xffff0000, v72
    v_lshlrev_b32 v22, 16, v73
    v_and_b32 v23, 0xffff0000, v73
    s_cmp_eq_u32 s48, 0
    s_cbranch_scc1 L_kv_na
    v_add_u32 v64, 69632, v0
    ds_read_b128 v[92:95], v64 offset:0
    ds_read_b128 v[96:99], v64 offset:1024
    ds_read_b128 v[100:103], v64 offset:2048
    ds_read_b128 v[104:107], v64 offset:3072
    v_mov_b32 v64, v84
    v_mov_b32 v65, v85
    v_lshrrev_b32 v66, 1, v65
    v_and_b32 v67, 1, v65
    s_lshr_b32 s97, s21, 1
    s_and_b32 s97, s97, 1
    s_lshl_b32 s98, s97, 6
    v_lshl_add_u32 v68, v64, 2, s98
    v_lshl_add_u32 v69, v65, 4, s98
    ds_bpermute_b32 v72, v68, v28
    ds_bpermute_b32 v76, v68, v26
    ds_bpermute_b32 v80, v69, v26 offset:0
    ds_bpermute_b32 v81, v69, v26 offset:4
    ds_bpermute_b32 v82, v69, v26 offset:8
    ds_bpermute_b32 v83, v69, v26 offset:12
    v_add_u32 v88, 146432, v0
    ds_read_b128 v[88:91], v88
    s_waitcnt lgkmcnt(7)
    v_pk_add_f32 v[92:93], v[92:93], v[96:97]
    v_pk_add_f32 v[100:101], v[100:101], v[104:105]
    v_pk_add_f32 v[94:95], v[94:95], v[98:99]
    v_pk_add_f32 v[102:103], v[102:103], v[106:107]
    v_pk_add_f32 v[84:85], v[92:93], v[100:101]
    v_pk_add_f32 v[86:87], v[94:95], v[102:103]
    s_bitcmp1_b32 s21, 0
    s_cbranch_scc1 L_kv_va
    s_waitcnt lgkmcnt(0)
    v_mov_b32 v73, v72
    v_mov_b32 v74, v72
    v_mov_b32 v75, v72
    s_nop 1
    v_mfma_f32_16x16x32_bf16 v[84:87], v[88:91], v[72:75], v[84:87]
    s_lshl_b32 s98, s97, 8
    v_lshl_add_u32 v71, v64, 4, s98
    v_lshl_add_u32 v71, v67, 9, v71
    v_lshl_add_u32 v71, v66, 3, v71
    s_nop 3
    v_mul_f32 v84, v76, v84
    v_mul_f32 v85, v76, v85
    v_mul_f32 v86, v76, v86
    v_mul_f32 v87, v76, v87
    s_branch L_kv_sta
L_kv_va:
    s_nop 1
    s_waitcnt lgkmcnt(0)
    v_mov_b32 v73, v72
    v_mov_b32 v74, v72
    v_mov_b32 v75, v72
    s_nop 1
    v_mfma_f32_16x16x32_bf16 v[84:87], v[72:75], v[88:91], v[84:87]
    s_lshl_b32 s98, s97, 9
    s_add_u32 s98, s98, 4096
    v_lshl_add_u32 v71, v64, 4, s98
    v_lshl_add_u32 v71, v66, 8, v71
    v_lshl_add_u32 v71, v67, 3, v71
    s_nop 2
    v_mul_f32 v84, v80, v84
    v_mul_f32 v85, v81, v85
    v_mul_f32 v86, v82, v86
    v_mul_f32 v87, v83, v87
L_kv_sta:
    v_cvt_pk_bf16_f32 v252, v84, v85
    v_cvt_pk_bf16_f32 v253, v86, v87
    v_mov_b32 v254, v71
    s_add_u32 s98, s77, 262144
    buffer_store_dwordx2 v[252:253], v254, s[4:7], s98 offen
L_kv_na:
    s_waitcnt vmcnt(17)
    v_xor_b32 v87, 64, v39
    ds_read_b64_tr_b16 v[180:181], v87 offset:0
    ds_read_b64_tr_b16 v[182:183], v87 offset:512
    ds_read_b64_tr_b16 v[184:185], v39 offset:0
    ds_read_b64_tr_b16 v[186:187], v39 offset:512
    ds_read_b64_tr_b16 v[188:189], v87 offset:2048
    ds_read_b64_tr_b16 v[190:191], v87 offset:2560
    ds_read_b64_tr_b16 v[192:193], v39 offset:2048
    ds_read_b64_tr_b16 v[194:195], v39 offset:2560
    s_waitcnt vmcnt(13)
    ds_read_b64_tr_b16 v[196:197], v87 offset:4096
    ds_read_b64_tr_b16 v[198:199], v87 offset:4608
    ds_read_b64_tr_b16 v[200:201], v39 offset:4096
    ds_read_b64_tr_b16 v[202:203], v39 offset:4608
    ds_read_b64_tr_b16 v[204:205], v87 offset:6144
    ds_read_b64_tr_b16 v[206:207], v87 offset:6656
    ds_read_b64_tr_b16 v[208:209], v39 offset:6144
    ds_read_b64_tr_b16 v[210:211], v39 offset:6656
    s_waitcnt lgkmcnt(8)
    v_dot2_f32_bf16 v32, v180, s29, 0
    v_dot2_f32_bf16 v33, v184, s29, 0
    v_dot2_f32_bf16 v32, v181, s29, v32
    v_dot2_f32_bf16 v33, v185, s29, v33
    v_dot2_f32_bf16 v32, v182, s29, v32
    v_dot2_f32_bf16 v33, v186, s29, v33
    v_dot2_f32_bf16 v32, v183, s29, v32
    v_dot2_f32_bf16 v33, v187, s29, v33
    v_dot2_f32_bf16 v32, v188, s29, v32
    v_dot2_f32_bf16 v33, v192, s29, v33
    v_dot2_f32_bf16 v32, v189, s29, v32
    v_dot2_f32_bf16 v33, v193, s29, v33
    v_dot2_f32_bf16 v32, v190, s29, v32
    v_dot2_f32_bf16 v33, v194, s29, v33
    v_dot2_f32_bf16 v32, v191, s29, v32
    v_dot2_f32_bf16 v33, v195, s29, v33
    s_waitcnt vmcnt(9)
    ds_read_b64_tr_b16 v[212:213], v87 offset:8192
    ds_read_b64_tr_b16 v[214:215], v87 offset:8704
    ds_read_b64_tr_b16 v[216:217], v39 offset:8192
    ds_read_b64_tr_b16 v[218:219], v39 offset:8704
    ds_read_b64_tr_b16 v[220:221], v87 offset:10240
    ds_read_b64_tr_b16 v[222:223], v87 offset:10752
    ds_read_b64_tr_b16 v[224:225], v39 offset:10240
    ds_read_b64_tr_b16 v[226:227], v39 offset:10752
    s_waitcnt lgkmcnt(8)
    v_dot2_f32_bf16 v32, v196, s29, v32
    v_dot2_f32_bf16 v33, v200, s29, v33
    v_dot2_f32_bf16 v32, v197, s29, v32
    v_dot2_f32_bf16 v33, v201, s29, v33
    v_dot2_f32_bf16 v32, v198, s29, v32
    v_dot2_f32_bf16 v33, v202, s29, v33
    v_dot2_f32_bf16 v32, v199, s29, v32
    v_dot2_f32_bf16 v33, v203, s29, v33
    v_dot2_f32_bf16 v32, v204, s29, v32
    v_dot2_f32_bf16 v33, v208, s29, v33
    v_dot2_f32_bf16 v32, v205, s29, v32
    v_dot2_f32_bf16 v33, v209, s29, v33
    v_dot2_f32_bf16 v32, v206, s29, v32
    v_dot2_f32_bf16 v33, v210, s29, v33
    v_dot2_f32_bf16 v32, v207, s29, v32
    v_dot2_f32_bf16 v33, v211, s29, v33
    s_waitcnt vmcnt(5)
    ds_read_b64_tr_b16 v[228:229], v87 offset:12288
    ds_read_b64_tr_b16 v[230:231], v87 offset:12800
    ds_read_b64_tr_b16 v[232:233], v39 offset:12288
    ds_read_b64_tr_b16 v[234:235], v39 offset:12800
    ds_read_b64_tr_b16 v[236:237], v87 offset:14336
    ds_read_b64_tr_b16 v[238:239], v87 offset:14848
    ds_read_b64_tr_b16 v[240:241], v39 offset:14336
    ds_read_b64_tr_b16 v[242:243], v39 offset:14848
    s_waitcnt lgkmcnt(8)
    v_dot2_f32_bf16 v32, v212, s29, v32
    v_dot2_f32_bf16 v33, v216, s29, v33
    v_dot2_f32_bf16 v32, v213, s29, v32
    v_dot2_f32_bf16 v33, v217, s29, v33
    v_dot2_f32_bf16 v32, v214, s29, v32
    v_dot2_f32_bf16 v33, v218, s29, v33
    v_dot2_f32_bf16 v32, v215, s29, v32
    v_dot2_f32_bf16 v33, v219, s29, v33
    v_dot2_f32_bf16 v32, v220, s29, v32
    v_dot2_f32_bf16 v33, v224, s29, v33
    v_dot2_f32_bf16 v32, v221, s29, v32
    v_dot2_f32_bf16 v33, v225, s29, v33
    v_dot2_f32_bf16 v32, v222, s29, v32
    v_dot2_f32_bf16 v33, v226, s29, v33
    v_dot2_f32_bf16 v32, v223, s29, v32
    v_dot2_f32_bf16 v33, v227, s29, v33
    s_waitcnt lgkmcnt(0)
    v_dot2_f32_bf16 v32, v228, s29, v32
    v_dot2_f32_bf16 v33, v232, s29, v33
    v_dot2_f32_bf16 v32, v229, s29, v32
    v_dot2_f32_bf16 v33, v233, s29, v33
    v_dot2_f32_bf16 v32, v230, s29, v32
    v_dot2_f32_bf16 v33, v234, s29, v33
    v_dot2_f32_bf16 v32, v231, s29, v32
    v_dot2_f32_bf16 v33, v235, s29, v33
    v_dot2_f32_bf16 v32, v236, s29, v32
    v_dot2_f32_bf16 v33, v240, s29, v33
    v_dot2_f32_bf16 v32, v237, s29, v32
    v_dot2_f32_bf16 v33, v241, s29, v33
    v_dot2_f32_bf16 v32, v238, s29, v32
    v_dot2_f32_bf16 v33, v242, s29, v33
    v_dot2_f32_bf16 v32, v239, s29, v32
    v_dot2_f32_bf16 v33, v243, s29, v33
    s_waitcnt lgkmcnt(0)
L_layer:
    v_mov_b32 v29, v28
    v_mov_b32 v30, v28
    v_mov_b32 v31, v28
    s_cmp_eq_u32 s48, 0
    s_cbranch_scc1 L_qplain
    buffer_store_dwordx2 v[252:253], v254, s[4:7], s77 offen sc1
    s_add_u32 s97, s78, s56
    s_waitcnt vmcnt(17)
    v_mfma_f32_32x32x16_bf16 v[44:59], v[180:183], v[108:111], 0
    v_mfma_f32_32x32x16_bf16 v[60:75], v[184:187], v[108:111], 0
    s_waitcnt vmcnt(16)
    v_mfma_f32_32x32x16_bf16 v[44:59], v[188:191], v[112:115], v[44:59]
    v_mfma_f32_32x32x16_bf16 v[60:75], v[192:195], v[112:115], v[60:75]
    s_waitcnt vmcnt(15)
    v_mfma_f32_32x32x16_bf16 v[44:59], v[196:199], v[116:119], v[44:59]
    v_mfma_f32_32x32x16_bf16 v[60:75], v[200:203], v[116:119], v[60:75]
    s_waitcnt vmcnt(14)
    v_mfma_f32_32x32x16_bf16 v[44:59], v[204:207], v[120:123], v[44:59]
    v_mfma_f32_32x32x16_bf16 v[60:75], v[208:211], v[120:123], v[60:75]
    s_waitcnt vmcnt(13)
    v_mfma_f32_32x32x16_bf16 v[44:59], v[212:215], v[124:127], v[44:59]
    v_mfma_f32_32x32x16_bf16 v[60:75], v[216:219], v[124:127], v[60:75]
    s_waitcnt vmcnt(12)
    v_mfma_f32_32x32x16_bf16 v[44:59], v[220:223], v[128:131], v[44:59]
    v_mfma_f32_32x32x16_bf16 v[60:75], v[224:227], v[128:131], v[60:75]
    s_waitcnt vmcnt(7)
    s_cmp_lg_u32 s25, 0
    s_cbranch_scc1 L_lf0
    s_waitcnt vmcnt(1)
L_lf0:
    s_mov_b64 exec, 1
    buffer_store_dword v36, off, s[4:7], s97 offset:2048
    s_mov_b64 exec, -1
    s_waitcnt vmcnt(12)
    v_mfma_f32_32x32x16_bf16 v[44:59], v[228:231], v[132:135], v[44:59]
    v_mfma_f32_32x32x16_bf16 v[60:75], v[232:235], v[132:135], v[60:75]
    s_waitcnt vmcnt(11)
    v_mfma_f32_32x32x16_bf16 v[44:59], v[236:239], v[136:139], v[44:59]
    v_mfma_f32_32x32x16_bf16 v[60:75], v[240:243], v[136:139], v[60:75]
    s_waitcnt vmcnt(10)
    v_mfma_f32_32x32x16_bf16 v[76:91], v[180:183], v[140:143], 0
    s_waitcnt vmcnt(9)
    v_mfma_f32_32x32x16_bf16 v[76:91], v[188:191], v[144:147], v[76:91]
    s_nop 6
    ds_write_b128 v42, v[44:47] offset:0
    s_waitcnt vmcnt(7)
    v_mfma_f32_32x32x16_bf16 v[76:91], v[196:199], v[148:151], v[76:91]
    ds_write_b128 v42, v[48:51] offset:1024
    ds_write_b128 v42, v[52:55] offset:2048
    s_waitcnt vmcnt(6)
    v_mfma_f32_32x32x16_bf16 v[76:91], v[204:207], v[152:155], v[76:91]
    v_mfma_f32_32x32x16_bf16 v[92:107], v[184:187], v[140:143], 0
    ds_write_b128 v42, v[56:59] offset:3072
    ds_write_b128 v41, v[60:63] offset:0
    s_waitcnt vmcnt(5)
    v_mfma_f32_32x32x16_bf16 v[76:91], v[212:215], v[156:159], v[76:91]
    v_mfma_f32_32x32x16_bf16 v[92:107], v[192:195], v[144:147], v[92:107]
    ds_write_b128 v41, v[64:67] offset:1024
    ds_write_b128 v41, v[68:71] offset:2048
    s_waitcnt vmcnt(4)
    v_mfma_f32_32x32x16_bf16 v[76:91], v[220:223], v[160:163], v[76:91]
    v_mfma_f32_32x32x16_bf16 v[92:107], v[200:203], v[148:151], v[92:107]
    ds_write_b128 v41, v[72:75] offset:3072
    s_waitcnt vmcnt(3)
    v_mfma_f32_32x32x16_bf16 v[76:91], v[228:231], v[164:167], v[76:91]
    v_mfma_f32_32x32x16_bf16 v[92:107], v[208:211], v[152:155], v[92:107]
    s_waitcnt vmcnt(2)
    v_mfma_f32_32x32x16_bf16 v[76:91], v[236:239], v[168:171], v[76:91]
    v_mfma_f32_32x32x16_bf16 v[92:107], v[216:219], v[156:159], v[92:107]
    s_waitcnt lgkmcnt(0)
    v_mfma_f32_32x32x16_bf16 v[92:107], v[224:227], v[160:163], v[92:107]
    v_mov_b32 v44, 0
    v_mov_b32 v45, 0
    v_mov_b32 v46, 0
    v_mov_b32 v47, 0
    v_mov_b32 v48, 0
    v_mov_b32 v49, 0
    v_mov_b32 v50, 0
    v_mov_b32 v51, 0
    v_mfma_f32_32x32x16_bf16 v[92:107], v[232:235], v[164:167], v[92:107]
    v_mov_b32 v52, 0
    v_mov_b32 v53, 0
    v_mov_b32 v54, 0
    v_mov_b32 v55, 0
    v_mov_b32 v56, 0
    v_mov_b32 v57, 0
    v_mov_b32 v58, 0
    v_mov_b32 v59, 0
    v_mfma_f32_32x32x16_bf16 v[92:107], v[240:243], v[168:171], v[92:107]
    v_mov_b32 v60, 0
    v_mov_b32 v61, 0
    v_mov_b32 v62, 0
    v_mov_b32 v63, 0
    v_mov_b32 v64, 0
    v_mov_b32 v65, 0
    v_mov_b32 v66, 0
    v_mov_b32 v67, 0
    ds_write_b128 v40, v[76:79] offset:0
    ds_write_b128 v40, v[80:83] offset:1024
    ds_write_b128 v40, v[84:87] offset:2048
    ds_write_b128 v40, v[88:91] offset:3072
    v_mov_b32 v68, 0
    v_mov_b32 v69, 0
    v_mov_b32 v70, 0
    v_mov_b32 v71, 0
    v_mov_b32 v72, 0
    v_mov_b32 v73, 0
    v_mov_b32 v74, 0
    v_mov_b32 v75, 0
    s_cmp_eq_u32 s48, 0
    s_cbranch_scc1 L_nog
    s_add_u32 s97, s78, s56
    s_waitcnt vmcnt(1)
    s_mov_b64 exec, 1
    buffer_store_dword v36, off, s[4:7], s97 offset:0 sc1
    s_mov_b64 exec, -1
L_nog:
    s_branch L_qjoin
L_qplain:
    s_and_b32 s99, s78, -128
    s_add_u32 s99, s99, 4096
    buffer_load_dword v7, v2, s[4:7], s99 offen offset:0 sc1
    s_waitcnt vmcnt(16)
    v_mfma_f32_32x32x16_bf16 v[44:59], v[180:183], v[108:111], 0
    v_mfma_f32_32x32x16_bf16 v[60:75], v[184:187], v[108:111], 0
    s_waitcnt vmcnt(15)
    v_mfma_f32_32x32x16_bf16 v[44:59], v[188:191], v[112:115], v[44:59]
    v_mfma_f32_32x32x16_bf16 v[60:75], v[192:195], v[112:115], v[60:75]
    s_waitcnt vmcnt(14)
    v_mfma_f32_32x32x16_bf16 v[44:59], v[196:199], v[116:119], v[44:59]
    v_mfma_f32_32x32x16_bf16 v[60:75], v[200:203], v[116:119], v[60:75]
    s_waitcnt vmcnt(13)
    v_mfma_f32_32x32x16_bf16 v[44:59], v[204:207], v[120:123], v[44:59]
    v_mfma_f32_32x32x16_bf16 v[60:75], v[208:211], v[120:123], v[60:75]
    s_waitcnt vmcnt(12)
    v_mfma_f32_32x32x16_bf16 v[44:59], v[212:215], v[124:127], v[44:59]
    v_mfma_f32_32x32x16_bf16 v[60:75], v[216:219], v[124:127], v[60:75]
    s_waitcnt vmcnt(11)
    v_mfma_f32_32x32x16_bf16 v[44:59], v[220:223], v[128:131], v[44:59]
    v_mfma_f32_32x32x16_bf16 v[60:75], v[224:227], v[128:131], v[60:75]
    s_waitcnt vmcnt(10)
    v_mfma_f32_32x32x16_bf16 v[44:59], v[228:231], v[132:135], v[44:59]
    v_mfma_f32_32x32x16_bf16 v[60:75], v[232:235], v[132:135], v[60:75]
    s_waitcnt vmcnt(9)
    v_mfma_f32_32x32x16_bf16 v[44:59], v[236:239], v[136:139], v[44:59]
    v_mfma_f32_32x32x16_bf16 v[60:75], v[240:243], v[136:139], v[60:75]
    s_waitcnt vmcnt(8)
    v_mfma_f32_32x32x16_bf16 v[76:91], v[180:183], v[140:143], 0
    s_waitcnt vmcnt(7)
    v_mfma_f32_32x32x16_bf16 v[76:91], v[188:191], v[144:147], v[76:91]
    s_nop 6
    ds_write_b128 v42, v[44:47] offset:0
    s_waitcnt vmcnt(6)
    v_mfma_f32_32x32x16_bf16 v[76:91], v[196:199], v[148:151], v[76:91]
    ds_write_b128 v42, v[48:51] offset:1024
    ds_write_b128 v42, v[52:55] offset:2048
    s_waitcnt vmcnt(5)
    v_mfma_f32_32x32x16_bf16 v[76:91], v[204:207], v[152:155], v[76:91]
    v_mfma_f32_32x32x16_bf16 v[92:107], v[184:187], v[140:143], 0
    ds_write_b128 v42, v[56:59] offset:3072
    ds_write_b128 v41, v[60:63] offset:0
    s_waitcnt vmcnt(4)
    v_mfma_f32_32x32x16_bf16 v[76:91], v[212:215], v[156:159], v[76:91]
    v_mfma_f32_32x32x16_bf16 v[92:107], v[192:195], v[144:147], v[92:107]
    ds_write_b128 v41, v[64:67] offset:1024
    ds_write_b128 v41, v[68:71] offset:2048
    s_waitcnt vmcnt(3)
    v_mfma_f32_32x32x16_bf16 v[76:91], v[220:223], v[160:163], v[76:91]
    v_mfma_f32_32x32x16_bf16 v[92:107], v[200:203], v[148:151], v[92:107]
    ds_write_b128 v41, v[72:75] offset:3072
    s_waitcnt vmcnt(2)
    v_mfma_f32_32x32x16_bf16 v[76:91], v[228:231], v[164:167], v[76:91]
    v_mfma_f32_32x32x16_bf16 v[92:107], v[208:211], v[152:155], v[92:107]
    s_waitcnt vmcnt(1)
    v_mfma_f32_32x32x16_bf16 v[76:91], v[236:239], v[168:171], v[76:91]
    v_mfma_f32_32x32x16_bf16 v[92:107], v[216:219], v[156:159], v[92:107]
    s_waitcnt lgkmcnt(0)
    v_mfma_f32_32x32x16_bf16 v[92:107], v[224:227], v[160:163], v[92:107]
    v_mov_b32 v44, 0
    v_mov_b32 v45, 0
    v_mov_b32 v46, 0
    v_mov_b32 v47, 0
    v_mov_b32 v48, 0
    v_mov_b32 v49, 0
    v_mov_b32 v50, 0
    v_mov_b32 v51, 0
    v_mfma_f32_32x32x16_bf16 v[92:107], v[232:235], v[164:167], v[92:107]
    v_mov_b32 v52, 0
    v_mov_b32 v53, 0
    v_mov_b32 v54, 0
    v_mov_b32 v55, 0
    v_mov_b32 v56, 0
    v_mov_b32 v57, 0
    v_mov_b32 v58, 0
    v_mov_b32 v59, 0
    v_mfma_f32_32x32x16_bf16 v[92:107], v[240:243], v[168:171], v[92:107]
    v_mov_b32 v60, 0
    v_mov_b32 v61, 0
    v_mov_b32 v62, 0
    v_mov_b32 v63, 0
    v_mov_b32 v64, 0
    v_mov_b32 v65, 0
    v_mov_b32 v66, 0
    v_mov_b32 v67, 0
    ds_write_b128 v40, v[76:79] offset:0
    ds_write_b128 v40, v[80:83] offset:1024
    ds_write_b128 v40, v[84:87] offset:2048
    ds_write_b128 v40, v[88:91] offset:3072
    v_mov_b32 v68, 0
    v_mov_b32 v69, 0
    v_mov_b32 v70, 0
    v_mov_b32 v71, 0
    v_mov_b32 v72, 0
    v_mov_b32 v73, 0
    v_mov_b32 v74, 0
    v_mov_b32 v75, 0
    s_waitcnt vmcnt(0)
L_qjoin:
    v_cmp_ne_u32 vcc, v36, v7
    s_lshl_b32 s97, s26, 10
    s_add_u32 s97, s97, 143360
    v_add_u32 v3, s97, v0
    s_cmp_eq_u64 vcc, 0
    s_cselect_b32 s98, 262144, 0
    s_cselect_b32 s99, 2048, 0
    s_add_u32 s98, s98, s54
    s_and_b32 s97, s78, -128
    s_add_u32 s99, s99, s97
    s_add_u32 s99, s99, s56
    s_cmp_eq_u32 s26, 0
    s_cbranch_scc1 L_noa0
    buffer_load_dword v7, v2, s[4:7], s99 offen offset:0 sc1
L_noa0:
    s_cmp_lg_u32 s25, 0
    s_cbranch_scc1 L_nojob
    v_cvt_pk_bf16_f32 v34, v32, v32
    v_lshlrev_b32 v34, 16, v34
    v_sub_f32 v34, v32, v34
    v_cvt_pk_bf16_f32 v32, v32, v34
    v_cvt_pk_bf16_f32 v34, v33, v33
    v_lshlrev_b32 v34, 16, v34
    v_sub_f32 v34, v33, v34
    v_cvt_pk_bf16_f32 v33, v33, v34
    s_lshl_b32 s97, s22, 2
    v_add_u32 v34, s97, v3
    v_xor_b32 v35, 1024, v34
    ds_write_b32 v35, v32
    ds_write_b32 v34, v33
    s_lshl_b32 s97, s22, 14
    s_add_u32 s97, s97, 73728
    v_add_u32 v27, s97, v0
    ds_write_b128 v27, v[172:175] offset:0
    ds_write_b128 v27, v[176:179] offset:1024
    ds_write_b128 v27, v[244:247] offset:2048
    ds_write_b128 v27, v[248:251] offset:3072
L_nojob:
    s_waitcnt lgkmcnt(0)
    s_barrier
    ds_read_b128 v[252:255], v3
    ds_read_b128 v[108:111], v6 offset:0
    ds_read_b128 v[112:115], v6 offset:1024
    ds_read_b128 v[116:119], v6 offset:2048
    ds_read_b128 v[120:123], v6 offset:3072
    ds_read_b128 v[124:127], v6 offset:4096
    ds_read_b128 v[128:131], v6 offset:5120
    ds_read_b128 v[132:135], v6 offset:6144
    ds_read_b128 v[136:139], v6 offset:7168
    ds_read_b128 v[140:143], v6 offset:8192
    ds_read_b128 v[144:147], v6 offset:9216
    ds_read_b128 v[148:151], v6 offset:10240
    ds_read_b128 v[152:155], v6 offset:11264
    s_cmp_eq_u32 s26, 0
    s_cbranch_scc1 L_noa
    s_lshl_b32 m0, s22, 12
    s_waitcnt vmcnt(0)
    v_xor_b32 v7, s23, v7
    v_cmp_lt_u32 vcc, 7, v7
    s_cbranch_vccnz L_spin_3
L_back_4:
    v_cmp_ne_u32 vcc, s55, v7
    buffer_load_dwordx4 v0, s[4:7], s98 offen offset:0 sc1 lds
    buffer_load_dwordx4 v0, s[4:7], s98 offen offset:1024 sc1 lds
    buffer_load_dwordx4 v0, s[4:7], s98 offen offset:2048 sc1 lds
    buffer_load_dwordx4 v0, s[4:7], s98 offen offset:3072 sc1 lds
    s_sub_u32 m0, m0, 4096
    s_sub_u32 s98, s98, 4096
    buffer_load_dwordx4 v0, s[4:7], s98 offen offset:0 sc1 lds
    buffer_load_dwordx4 v0, s[4:7], s98 offen offset:1024 sc1 lds
    buffer_load_dwordx4 v0, s[4:7], s98 offen offset:2048 sc1 lds
    buffer_load_dwordx4 v0, s[4:7], s98 offen offset:3072 sc1 lds
    s_and_b32 s97, s20, 3
    s_lshl_b32 s97, s97, 3
    s_lshr_b32 s97, vcc_lo, s97
    s_and_b32 s97, s97, 0xff
    s_cselect_b32 s97, 0, 1
    v_mov_b32 v3, s97
    v_mov_b32 v7, 145408
    s_waitcnt lgkmcnt(0)
    ds_write_b32 v7, v3
L_noa:
    s_waitcnt lgkmcnt(12)
    v_mfma_f32_32x32x16_bf16 v[92:107], v[252:255], v[28:31], v[92:107]
    v_mul_f32 v26, 0x3eb8aa3b, v26
    s_waitcnt lgkmcnt(4)
    v_pk_add_f32 v[108:109], v[108:109], v[124:125]
    v_pk_add_f32 v[110:111], v[110:111], v[126:127]
    v_pk_add_f32 v[112:113], v[112:113], v[128:129]
    v_pk_add_f32 v[114:115], v[114:115], v[130:131]
    v_pk_add_f32 v[116:117], v[116:117], v[132:133]
    v_pk_add_f32 v[118:119], v[118:119], v[134:135]
    v_pk_add_f32 v[120:121], v[120:121], v[136:137]
    v_pk_add_f32 v[122:123], v[122:123], v[138:139]
    s_waitcnt lgkmcnt(0)
    v_pk_add_f32 v[108:109], v[108:109], v[140:141]
    v_pk_add_f32 v[110:111], v[110:111], v[142:143]
    v_pk_add_f32 v[112:113], v[112:113], v[144:145]
    v_pk_add_f32 v[114:115], v[114:115], v[146:147]
    v_pk_add_f32 v[116:117], v[116:117], v[148:149]
    v_pk_add_f32 v[118:119], v[118:119], v[150:151]
    v_pk_add_f32 v[120:121], v[120:121], v[152:153]
    v_pk_add_f32 v[122:123], v[122:123], v[154:155]
    v_pk_add_f32 v[108:109], v[108:109], v[92:93]
    v_pk_add_f32 v[110:111], v[110:111], v[94:95]
    v_pk_add_f32 v[112:113], v[112:113], v[96:97]
    v_pk_add_f32 v[114:115], v[114:115], v[98:99]
    v_pk_add_f32 v[116:117], v[116:117], v[100:101]
    v_pk_add_f32 v[118:119], v[118:119], v[102:103]
    v_pk_add_f32 v[120:121], v[120:121], v[104:105]
    v_pk_add_f32 v[122:123], v[122:123], v[106:107]
    v_pk_mul_f32 v[108:109], v[108:109], v[26:27] op_sel_hi:[1,0]
    v_pk_mul_f32 v[110:111], v[110:111], v[26:27] op_sel_hi:[1,0]
    v_pk_mul_f32 v[112:113], v[112:113], v[26:27] op_sel_hi:[1,0]
    v_pk_mul_f32 v[114:115], v[114:115], v[26:27] op_sel_hi:[1,0]
    v_pk_mul_f32 v[116:117], v[116:117], v[26:27] op_sel_hi:[1,0]
    v_pk_mul_f32 v[118:119], v[118:119], v[26:27] op_sel_hi:[1,0]
    v_pk_mul_f32 v[120:121], v[120:121], v[26:27] op_sel_hi:[1,0]
    v_pk_mul_f32 v[122:123], v[122:123], v[26:27] op_sel_hi:[1,0]
    v_cvt_pk_bf16_f32 v140, v108, v109
    v_cvt_pk_bf16_f32 v141, v110, v111
    v_cvt_pk_bf16_f32 v142, v112, v113
    v_cvt_pk_bf16_f32 v143, v114, v115
    v_cvt_pk_bf16_f32 v144, v116, v117
    v_cvt_pk_bf16_f32 v145, v118, v119
    v_cvt_pk_bf16_f32 v146, v120, v121
    v_cvt_pk_bf16_f32 v147, v122, v123
    s_cmp_lg_u32 s25, 0
    s_cbranch_scc1 L_nojob2
    ds_read_b64_tr_b16 v[172:173], v24 offset:0
    ds_read_b64_tr_b16 v[174:175], v25 offset:0
    ds_read_b64_tr_b16 v[176:177], v24 offset:2048
    ds_read_b64_tr_b16 v[178:179], v25 offset:2048
    ds_read_b64_tr_b16 v[244:245], v24 offset:16384
    ds_read_b64_tr_b16 v[246:247], v25 offset:16384
    ds_read_b64_tr_b16 v[248:249], v24 offset:18432
    ds_read_b64_tr_b16 v[250:251], v25 offset:18432
    s_waitcnt lgkmcnt(0)
    buffer_store_dwordx4 v[172:175], v0, s[4:7], s100 offen offset:0 sc1
    buffer_store_dwordx4 v[176:179], v0, s[4:7], s100 offen offset:1024 sc1
    buffer_store_dwordx4 v[244:247], v0, s[4:7], s100 offen offset:2048 sc1
    buffer_store_dwordx4 v[248:251], v0, s[4:7], s100 offen offset:3072 sc1
    v_dot2_f32_bf16 v86, v172, s29, 0
    v_dot2_f32_bf16 v86, v173, s29, v86
    v_dot2_f32_bf16 v86, v174, s29, v86
    v_dot2_f32_bf16 v86, v175, s29, v86
    v_dot2_f32_bf16 v86, v176, s29, v86
    v_dot2_f32_bf16 v86, v177, s29, v86
    v_dot2_f32_bf16 v86, v178, s29, v86
    v_dot2_f32_bf16 v86, v179, s29, v86
    v_dot2_f32_bf16 v86, v244, s29, v86
    v_dot2_f32_bf16 v86, v245, s29, v86
    v_dot2_f32_bf16 v86, v246, s29, v86
    v_dot2_f32_bf16 v86, v247, s29, v86
    v_dot2_f32_bf16 v86, v248, s29, v86
    v_dot2_f32_bf16 v86, v249, s29, v86
    v_dot2_f32_bf16 v86, v250, s29, v86
    v_dot2_f32_bf16 v86, v251, s29, v86
    s_nop 2
    v_mov_b32 v87, v86
    s_nop 1
    v_permlane32_swap_b32 v86, v87
    v_add_f32 v86, v86, v87
    v_cvt_pk_bf16_f32 v87, v86, v86
    v_lshlrev_b32 v87, 16, v87
    v_sub_f32 v87, v86, v87
    v_cvt_pk_bf16_f32 v108, v86, v87
    v_lshlrev_b32 v87, 2, v2
    buffer_store_dword v108, v87, s[4:7], s101 offen sc1
L_nojob2:
    v_and_b32 v24, 15, v1
    v_lshlrev_b32 v24, 7, v24
    v_min_u32 v25, 23, v1
    v_lshlrev_b32 v25, 7, v25
    s_and_b32 s97, s20, 3
    s_mul_i32 s97, s97, 3072
    v_add_u32 v25, s97, v25
    s_lshl_b32 s97, s25, 29
    v_add_u32 v28, s97, v24
    v_add_u32 v29, s97, v0
    v_lshlrev_b32 v30, 8, v2
    v_mov_b32 v172, 0xdddd
    v_and_b32 v80, 15, v1
    v_lshrrev_b32 v81, 5, v1
    v_lshlrev_b32 v80, 4, v80
    v_lshl_add_u32 v80, v81, 8, v80
    v_and_b32 v81, 16, v1
    v_cmp_eq_u32 vcc, 0, v81
    v_mov_b32 v82, 139264
    v_mov_b32 v83, 4096
    v_cndmask_b32 v82, v82, v83, vcc
    v_add_u32 v176, v80, v82
    v_mov_b32 v83, 8192
    v_cndmask_b32 v175, 0, v83, vcc
    v_mov_b32 v174, v176
    v_mov_b32 v173, v0
    s_mov_b32 s38, 0
    s_mov_b32 s96, 5120
    s_lshr_b32 s94, s20, 2
    s_lshl_b32 s94, s94, 3
    s_lshl_b64 s[92:93], 0xff, s94
    s_lshl_b32 s95, s22, 12
    v_mov_b32 v7, 145408
    s_cmp_eq_u32 s26, 0
    s_cbranch_scc1 L_noa2
    s_waitcnt vmcnt(5) lgkmcnt(0)
    s_cmp_eq_u32 s25, 0
    s_cbranch_scc1 L_noa2
    s_waitcnt vmcnt(0)
L_noa2:
    s_barrier
    ds_read_b128 v[148:151], v173
    ds_read_b128 v[152:155], v173 offset:1024
    ds_read_b128 v[156:159], v174
    ds_read_b128 v[164:167], v174 offset:512
    ds_read_b32 v179, v7
    s_waitcnt lgkmcnt(4)
    v_mfma_f32_32x32x16_bf16 v[108:123], v[148:151], v[140:143], 0
    v_mfma_f32_32x32x16_bf16 v[124:139], v[148:151], v[144:147], 0
    s_nop 10
    v_max_f32 v177, v108, v109
    v_max3_f32 v177, v177, v110, v111
    v_max3_f32 v177, v177, v112, v113
    v_max3_f32 v177, v177, v114, v115
    v_max3_f32 v177, v177, v116, v117
    v_max3_f32 v177, v177, v118, v119
    v_max3_f32 v177, v177, v120, v121
    v_max3_f32 v177, v177, v122, v123
    v_max_f32 v178, v124, v125
    v_max3_f32 v178, v178, v126, v127
    v_max3_f32 v178, v178, v128, v129
    v_max3_f32 v178, v178, v130, v131
    v_max3_f32 v178, v178, v132, v133
    v_max3_f32 v178, v178, v134, v135
    v_max3_f32 v178, v178, v136, v137
    v_max3_f32 v178, v178, v138, v139
    v_mov_b32 v3, v177
    v_mov_b32 v7, v178
    s_nop 0
    v_permlane32_swap_b32 v3, v177
    v_permlane32_swap_b32 v7, v178
    v_max_f32 v3, v3, v177
    v_max_f32 v7, v7, v178
    v_sub_f32 v76, 0, v3
    v_sub_f32 v77, 0, v3
    v_sub_f32 v78, 0, v3
    v_sub_f32 v79, 0, v3
    v_sub_f32 v80, 0, v3
    v_sub_f32 v81, 0, v3
    v_sub_f32 v82, 0, v3
    v_sub_f32 v83, 0, v3
    v_sub_f32 v84, 0, v3
    v_sub_f32 v85, 0, v3
    v_sub_f32 v86, 0, v3
    v_sub_f32 v87, 0, v3
    v_sub_f32 v88, 0, v3
    v_sub_f32 v89, 0, v3
    v_sub_f32 v90, 0, v3
    v_sub_f32 v91, 0, v3
    s_waitcnt lgkmcnt(0)
    s_nop 0
    v_mfma_f32_32x32x16_bf16 v[108:123], v[148:151], v[140:143], v[76:91]
    v_sub_f32 v92, 0, v7
    v_sub_f32 v93, 0, v7
    v_sub_f32 v94, 0, v7
    v_sub_f32 v95, 0, v7
    v_sub_f32 v96, 0, v7
    v_sub_f32 v97, 0, v7
    v_sub_f32 v98, 0, v7
    v_sub_f32 v99, 0, v7
    v_sub_f32 v100, 0, v7
    v_sub_f32 v101, 0, v7
    v_sub_f32 v102, 0, v7
    v_sub_f32 v103, 0, v7
    v_sub_f32 v104, 0, v7
    v_sub_f32 v105, 0, v7
    v_sub_f32 v106, 0, v7
    v_sub_f32 v107, 0, v7
.p2align 3
    v_exp_f32 v108, v108
    v_exp_f32 v109, v109
    v_exp_f32 v110, v110
    v_exp_f32 v111, v111
    v_exp_f32 v112, v112
    v_exp_f32 v113, v113
    v_mfma_f32_32x32x16_bf16 v[124:139], v[148:151], v[144:147], v[92:107]
    ds_read_b128 v[148:151], v173 offset:2048
    v_exp_f32 v114, v114
    v_exp_f32 v115, v115
    ds_read_b128 v[160:163], v174 offset:1024
    v_exp_f32 v116, v116
    v_exp_f32 v117, v117
    v_smfmac_f32_32x32x32_bf16 v[44:59], v[156:159], v[108:115], v172
    ds_read_b128 v[168:171], v174 offset:1536
    v_exp_f32 v118, v118
    v_exp_f32 v119, v119
    v_exp_f32 v120, v120
    v_exp_f32 v121, v121
    v_exp_f32 v122, v122
    v_exp_f32 v123, v123
    v_exp_f32 v124, v124
    v_exp_f32 v125, v125
    v_smfmac_f32_32x32x32_bf16 v[44:59], v[164:167], v[116:123], v172
    v_exp_f32 v126, v126
    v_exp_f32 v127, v127
    v_exp_f32 v128, v128
    v_exp_f32 v129, v129
    v_mfma_f32_32x32x16_bf16 v[108:123], v[152:155], v[140:143], v[76:91]
    v_exp_f32 v130, v130
    v_exp_f32 v131, v131
    v_exp_f32 v132, v132
    v_exp_f32 v133, v133
    v_smfmac_f32_32x32x32_bf16 v[60:75], v[156:159], v[124:131], v172
    s_waitcnt lgkmcnt(0)
    v_exp_f32 v134, v134
    v_exp_f32 v135, v135
    v_exp_f32 v136, v136
    v_exp_f32 v137, v137
    v_exp_f32 v138, v138
    v_exp_f32 v139, v139
    v_exp_f32 v108, v108
    v_exp_f32_e64 v109, v109
    v_smfmac_f32_32x32x32_bf16 v[60:75], v[164:167], v[132:139], v172
    v_exp_f32 v110, v110
    v_exp_f32 v111, v111
    v_exp_f32 v112, v112
    v_exp_f32 v113, v113
    v_mfma_f32_32x32x16_bf16 v[124:139], v[152:155], v[144:147], v[92:107]
    ds_read_b128 v[152:155], v173 offset:3072
    v_exp_f32 v114, v114
    v_exp_f32 v115, v115
    ds_read_b128 v[156:159], v174 offset:2048
    v_exp_f32 v116, v116
    v_exp_f32 v117, v117
    v_smfmac_f32_32x32x32_bf16 v[44:59], v[160:163], v[108:115], v172
    ds_read_b128 v[164:167], v174 offset:2560
    v_exp_f32 v118, v118
    v_exp_f32 v119, v119
    v_exp_f32 v120, v120
    v_exp_f32 v121, v121
    v_exp_f32 v122, v122
    v_exp_f32 v123, v123
    v_exp_f32 v124, v124
    v_exp_f32 v125, v125
    v_smfmac_f32_32x32x32_bf16 v[44:59], v[168:171], v[116:123], v172
    v_exp_f32 v126, v126
    v_exp_f32 v127, v127
    v_exp_f32 v128, v128
    v_exp_f32 v129, v129
    v_mfma_f32_32x32x16_bf16 v[108:123], v[148:151], v[140:143], v[76:91]
    v_exp_f32 v130, v130
    v_exp_f32 v131, v131
    v_exp_f32 v132, v132
    v_exp_f32 v133, v133
    v_smfmac_f32_32x32x32_bf16 v[60:75], v[160:163], v[124:131], v172
    s_waitcnt lgkmcnt(0)
    v_exp_f32 v134, v134
    v_exp_f32 v135, v135
    v_exp_f32 v136, v136
    v_exp_f32 v137, v137
    v_exp_f32 v138, v138
    v_exp_f32 v139, v139
    v_exp_f32 v108, v108
    v_exp_f32_e64 v109, v109
    v_smfmac_f32_32x32x32_bf16 v[60:75], v[168:171], v[132:139], v172
    v_exp_f32 v110, v110
    v_exp_f32 v111, v111
    v_exp_f32 v112, v112
    v_exp_f32 v113, v113
    v_mfma_f32_32x32x16_bf16 v[124:139], v[148:151], v[144:147], v[92:107]
    buffer_load_dwordx4 v[252:255], v0, s[4:7], s56 offen sc1
    ds_read_b128 v[148:151], v173 offset:8192
    v_exp_f32 v114, v114
    v_exp_f32 v115, v115
    ds_read_b128 v[160:163], v174 offset:3072
    v_exp_f32 v116, v116
    v_exp_f32 v117, v117
    v_smfmac_f32_32x32x32_bf16 v[44:59], v[156:159], v[108:115], v172
    ds_read_b128 v[168:171], v174 offset:3584
    v_exp_f32 v118, v118
    v_exp_f32 v119, v119
    v_exp_f32 v120, v120
    v_exp_f32 v121, v121
    v_exp_f32 v122, v122
    v_exp_f32 v123, v123
    v_exp_f32 v124, v124
    v_exp_f32 v125, v125
    v_smfmac_f32_32x32x32_bf16 v[44:59], v[164:167], v[116:123], v172
    v_exp_f32 v126, v126
    v_exp_f32 v127, v127
    v_exp_f32 v128, v128
    v_exp_f32 v129, v129
    v_mfma_f32_32x32x16_bf16 v[108:123], v[152:155], v[140:143], v[76:91]
    v_exp_f32 v130, v130
    v_exp_f32 v131, v131
    v_exp_f32 v132, v132
    v_exp_f32 v133, v133
    v_smfmac_f32_32x32x32_bf16 v[60:75], v[156:159], v[124:131], v172
    s_waitcnt lgkmcnt(0)
    v_exp_f32 v134, v134
    v_exp_f32 v135, v135
    v_exp_f32 v136, v136
    v_exp_f32 v137, v137
    v_exp_f32 v138, v138
    v_exp_f32 v139, v139
    v_exp_f32 v108, v108
    v_exp_f32_e64 v109, v109
    v_smfmac_f32_32x32x32_bf16 v[60:75], v[164:167], v[132:139], v172
    v_exp_f32 v110, v110
    v_exp_f32 v111, v111
    v_exp_f32 v112, v112
    v_exp_f32 v113, v113
    v_mfma_f32_32x32x16_bf16 v[124:139], v[152:155], v[144:147], v[92:107]
    ds_read_b128 v[152:155], v173 offset:9216
    v_add_u32 v174, v175, v174
    v_exp_f32 v114, v114
    v_exp_f32_e64 v115, v115
    ds_read_b128 v[156:159], v174 offset:0
    v_exp_f32 v116, v116
    v_exp_f32 v117, v117
    v_smfmac_f32_32x32x32_bf16 v[44:59], v[160:163], v[108:115], v172
    ds_read_b128 v[164:167], v174 offset:512
    v_exp_f32 v118, v118
    v_exp_f32 v119, v119
    v_exp_f32 v120, v120
    v_exp_f32 v121, v121
    v_exp_f32 v122, v122
    v_exp_f32 v123, v123
    v_exp_f32 v124, v124
    v_exp_f32 v125, v125
    v_smfmac_f32_32x32x32_bf16 v[44:59], v[168:171], v[116:123], v172
    v_exp_f32 v126, v126
    v_exp_f32 v127, v127
    v_exp_f32 v128, v128
    v_exp_f32 v129, v129
    v_mfma_f32_32x32x16_bf16 v[108:123], v[148:151], v[140:143], v[76:91]
    v_exp_f32 v130, v130
    v_exp_f32 v131, v131
    v_exp_f32 v132, v132
    v_exp_f32 v133, v133
    v_smfmac_f32_32x32x32_bf16 v[60:75], v[160:163], v[124:131], v172
    s_waitcnt lgkmcnt(0)
    v_exp_f32 v134, v134
    v_exp_f32 v135, v135
    v_exp_f32_e64 v136, v136
    s_waitcnt vmcnt(0)
    v_xor_b32 v252, s23, v252
    v_xor_b32 v253, s23, v253
    v_xor_b32 v254, s23, v254
    v_xor_b32 v255, s23, v255
    v_or3_b32 v252, v252, v253, v254
    v_or_b32 v252, v252, v255
    v_cmp_lt_u32 vcc, 7, v252
    s_nop 0
    s_andn2_b64 vcc, vcc, s[92:93]
    s_cbranch_scc1 L_spin_5
L_back_6:
    v_exp_f32 v137, v137
    v_exp_f32 v138, v138
    v_exp_f32 v139, v139
    v_exp_f32 v108, v108
    v_exp_f32_e64 v109, v109
    v_smfmac_f32_32x32x32_bf16 v[60:75], v[168:171], v[132:139], v172
    v_exp_f32 v110, v110
    v_exp_f32 v111, v111
    v_exp_f32 v112, v112
    v_exp_f32 v113, v113
    v_mfma_f32_32x32x16_bf16 v[124:139], v[148:151], v[144:147], v[92:107]
    s_add_u32 m0, s95, 16384
    s_xor_b32 s94, s54, 16384
    buffer_load_dwordx4 v0, s[4:7], s94 offen offset:0 sc1 lds
    ds_read_b128 v[148:151], v173 offset:10240
    v_exp_f32 v114, v114
    v_exp_f32 v115, v115
    ds_read_b128 v[160:163], v174 offset:1024
    v_exp_f32 v116, v116
    v_exp_f32 v117, v117
    v_smfmac_f32_32x32x32_bf16 v[44:59], v[156:159], v[108:115], v172
    ds_read_b128 v[168:171], v174 offset:1536
    v_exp_f32 v118, v118
    v_exp_f32 v119, v119
    v_exp_f32_e64 v120, v120
    buffer_load_dwordx4 v0, s[4:7], s94 offen offset:1024 sc1 lds
    v_exp_f32 v121, v121
    v_exp_f32 v122, v122
    v_exp_f32 v123, v123
    v_exp_f32 v124, v124
    v_exp_f32_e64 v125, v125
    v_smfmac_f32_32x32x32_bf16 v[44:59], v[164:167], v[116:123], v172
    v_exp_f32 v126, v126
    v_exp_f32 v127, v127
    v_exp_f32 v128, v128
    v_exp_f32 v129, v129
    v_mfma_f32_32x32x16_bf16 v[108:123], v[152:155], v[140:143], v[76:91]
    v_exp_f32 v130, v130
    v_exp_f32 v131, v131
    buffer_load_dwordx4 v0, s[4:7], s94 offen offset:2048 sc1 lds
    v_exp_f32 v132, v132
    v_exp_f32 v133, v133
    v_smfmac_f32_32x32x32_bf16 v[60:75], v[156:159], v[124:131], v172
    s_waitcnt lgkmcnt(0)
    v_exp_f32 v134, v134
    v_exp_f32 v135, v135
    v_exp_f32 v136, v136
    buffer_load_dwordx4 v0, s[4:7], s94 offen offset:3072 sc1 lds
    v_exp_f32 v137, v137
    v_exp_f32 v138, v138
    v_exp_f32 v139, v139
    v_exp_f32 v108, v108
    v_exp_f32_e64 v109, v109
    v_smfmac_f32_32x32x32_bf16 v[60:75], v[164:167], v[132:139], v172
    v_exp_f32 v110, v110
    v_exp_f32 v111, v111
    v_exp_f32 v112, v112
    v_exp_f32 v113, v113
    v_mfma_f32_32x32x16_bf16 v[124:139], v[152:155], v[144:147], v[92:107]
    s_add_u32 m0, s95, 32768
    s_xor_b32 s94, s54, 32768
    buffer_load_dwordx4 v0, s[4:7], s94 offen offset:0 sc1 lds
    ds_read_b128 v[152:155], v173 offset:11264
    v_exp_f32 v114, v114
    v_exp_f32 v115, v115
    ds_read_b128 v[156:159], v174 offset:2048
    v_exp_f32 v116, v116
    v_exp_f32 v117, v117
    v_smfmac_f32_32x32x32_bf16 v[44:59], v[160:163], v[108:115], v172
    ds_read_b128 v[164:167], v174 offset:2560
    v_exp_f32 v118, v118
    v_exp_f32 v119, v119
    v_exp_f32_e64 v120, v120
    buffer_load_dwordx4 v0, s[4:7], s94 offen offset:1024 sc1 lds
    v_exp_f32 v121, v121
    v_exp_f32 v122, v122
    v_exp_f32 v123, v123
    v_exp_f32 v124, v124
    v_exp_f32_e64 v125, v125
    v_smfmac_f32_32x32x32_bf16 v[44:59], v[168:171], v[116:123], v172
    v_exp_f32 v126, v126
    v_exp_f32 v127, v127
    v_exp_f32 v128, v128
    v_exp_f32 v129, v129
    v_mfma_f32_32x32x16_bf16 v[108:123], v[148:151], v[140:143], v[76:91]
    v_exp_f32 v130, v130
    v_exp_f32 v131, v131
    buffer_load_dwordx4 v0, s[4:7], s94 offen offset:2048 sc1 lds
    v_exp_f32 v132, v132
    v_exp_f32 v133, v133
    v_smfmac_f32_32x32x32_bf16 v[60:75], v[160:163], v[124:131], v172
    s_waitcnt lgkmcnt(0)
    v_exp_f32 v134, v134
    v_exp_f32 v135, v135
    v_exp_f32 v136, v136
    buffer_load_dwordx4 v0, s[4:7], s94 offen offset:3072 sc1 lds
    v_exp_f32 v137, v137
    v_exp_f32 v138, v138
    v_exp_f32 v139, v139
    v_exp_f32 v108, v108
    v_exp_f32_e64 v109, v109
    v_smfmac_f32_32x32x32_bf16 v[60:75], v[168:171], v[132:139], v172
    v_exp_f32 v110, v110
    v_exp_f32 v111, v111
    v_exp_f32 v112, v112
    v_exp_f32 v113, v113
    v_mfma_f32_32x32x16_bf16 v[124:139], v[148:151], v[144:147], v[92:107]
    s_waitcnt vmcnt(4)
    s_barrier
    s_add_u32 m0, s95, 49152
    s_xor_b32 s94, s54, 49152
    buffer_load_dwordx4 v0, s[4:7], s94 offen offset:0 sc1 lds
    ds_read_b128 v[148:151], v173 offset:16384
    v_exp_f32 v114, v114
    v_exp_f32 v115, v115
    ds_read_b128 v[160:163], v174 offset:3072
    v_exp_f32 v116, v116
    v_exp_f32 v117, v117
    v_smfmac_f32_32x32x32_bf16 v[44:59], v[156:159], v[108:115], v172
    ds_read_b128 v[168:171], v174 offset:3584
    v_exp_f32 v118, v118
    v_exp_f32 v119, v119
    v_exp_f32_e64 v120, v120
    buffer_load_dwordx4 v0, s[4:7], s94 offen offset:1024 sc1 lds
    v_exp_f32 v121, v121
    v_exp_f32 v122, v122
    v_exp_f32 v123, v123
    v_exp_f32 v124, v124
    v_exp_f32_e64 v125, v125
    v_smfmac_f32_32x32x32_bf16 v[44:59], v[164:167], v[116:123], v172
    v_exp_f32 v126, v126
    v_exp_f32 v127, v127
    v_exp_f32 v128, v128
    v_exp_f32 v129, v129
    v_mfma_f32_32x32x16_bf16 v[108:123], v[152:155], v[140:143], v[76:91]
    v_exp_f32 v130, v130
    v_exp_f32 v131, v131
    buffer_load_dwordx4 v0, s[4:7], s94 offen offset:2048 sc1 lds
    s_or_b32 s97, s25, s22
    s_cbranch_scc1 L_nor_7
    s_add_u32 s97, s78, 5120
    s_mov_b64 exec, 1
    buffer_store_dword v36, off, s[4:7], s97 offset:0 sc1
    s_mov_b64 exec, -1
L_nor_7:
    v_exp_f32 v132, v132
    v_exp_f32 v133, v133
    v_smfmac_f32_32x32x32_bf16 v[60:75], v[156:159], v[124:131], v172
    s_waitcnt lgkmcnt(0)
    v_exp_f32 v134, v134
    v_exp_f32 v135, v135
    v_exp_f32 v136, v136
    buffer_load_dwordx4 v0, s[4:7], s94 offen offset:3072 sc1 lds
    v_exp_f32 v137, v137
    v_exp_f32 v138, v138
    v_exp_f32 v139, v139
    v_exp_f32 v108, v108
    v_exp_f32_e64 v109, v109
    v_smfmac_f32_32x32x32_bf16 v[60:75], v[164:167], v[132:139], v172
    v_exp_f32 v110, v110
    v_exp_f32 v111, v111
    v_exp_f32 v112, v112
    v_exp_f32 v113, v113
    v_mfma_f32_32x32x16_bf16 v[124:139], v[152:155], v[144:147], v[92:107]
    s_add_u32 m0, s95, 65536
    s_xor_b32 s94, s54, 65536
    buffer_load_dwordx4 v0, s[4:7], s94 offen offset:0 sc1 lds
    ds_read_b128 v[152:155], v173 offset:17408
    v_add_u32 v174, v175, v174
    v_exp_f32 v114, v114
    v_exp_f32_e64 v115, v115
    ds_read_b128 v[156:159], v174 offset:0
    v_exp_f32 v116, v116
    v_exp_f32 v117, v117
    v_smfmac_f32_32x32x32_bf16 v[44:59], v[160:163], v[108:115], v172
    ds_read_b128 v[164:167], v174 offset:512
    v_exp_f32 v118, v118
    v_exp_f32 v119, v119
    v_exp_f32_e64 v120, v120
    buffer_load_dwordx4 v0, s[4:7], s94 offen offset:1024 sc1 lds
    v_exp_f32 v121, v121
    v_exp_f32 v122, v122
    v_exp_f32 v123, v123
    v_exp_f32 v124, v124
    v_exp_f32_e64 v125, v125
    v_smfmac_f32_32x32x32_bf16 v[44:59], v[168:171], v[116:123], v172
    v_exp_f32 v126, v126
    v_exp_f32 v127, v127
    v_exp_f32 v128, v128
    v_exp_f32 v129, v129
    v_mfma_f32_32x32x16_bf16 v[108:123], v[148:151], v[140:143], v[76:91]
    v_exp_f32 v130, v130
    v_exp_f32 v131, v131
    buffer_load_dwordx4 v0, s[4:7], s94 offen offset:2048 sc1 lds
    v_exp_f32 v132, v132
    v_exp_f32 v133, v133
    v_smfmac_f32_32x32x32_bf16 v[60:75], v[160:163], v[124:131], v172
    s_waitcnt lgkmcnt(0)
    v_exp_f32 v134, v134
    v_exp_f32 v135, v135
    v_exp_f32 v136, v136
    buffer_load_dwordx4 v0, s[4:7], s94 offen offset:3072 sc1 lds
    v_exp_f32 v137, v137
    v_exp_f32 v138, v138
    v_exp_f32 v139, v139
    v_exp_f32 v108, v108
    v_exp_f32_e64 v109, v109
    v_smfmac_f32_32x32x32_bf16 v[60:75], v[168:171], v[132:139], v172
    v_exp_f32 v110, v110
    v_exp_f32 v111, v111
    v_exp_f32 v112, v112
    v_exp_f32 v113, v113
    v_mfma_f32_32x32x16_bf16 v[124:139], v[148:151], v[144:147], v[92:107]
    s_add_u32 m0, s95, 81920
    s_xor_b32 s94, s54, 81920
    buffer_load_dwordx4 v0, s[4:7], s94 offen offset:0 sc1 lds
    ds_read_b128 v[148:151], v173 offset:18432
    v_exp_f32 v114, v114
    v_exp_f32 v115, v115
    ds_read_b128 v[160:163], v174 offset:1024
    v_exp_f32 v116, v116
    v_exp_f32 v117, v117
    v_smfmac_f32_32x32x32_bf16 v[44:59], v[156:159], v[108:115], v172
    ds_read_b128 v[168:171], v174 offset:1536
    v_exp_f32 v118, v118
    v_exp_f32 v119, v119
    v_exp_f32_e64 v120, v120
    buffer_load_dwordx4 v0, s[4:7], s94 offen offset:1024 sc1 lds
    v_exp_f32 v121, v121
    v_exp_f32 v122, v122
    v_exp_f32 v123, v123
    v_exp_f32 v124, v124
    v_exp_f32_e64 v125, v125
    v_smfmac_f32_32x32x32_bf16 v[44:59], v[164:167], v[116:123], v172
    v_exp_f32 v126, v126
    v_exp_f32 v127, v127
    v_exp_f32 v128, v128
    v_exp_f32 v129, v129
    v_mfma_f32_32x32x16_bf16 v[108:123], v[152:155], v[140:143], v[76:91]
    v_exp_f32 v130, v130
    v_exp_f32 v131, v131
    buffer_load_dwordx4 v0, s[4:7], s94 offen offset:2048 sc1 lds
    v_exp_f32 v132, v132
    v_exp_f32 v133, v133
    v_smfmac_f32_32x32x32_bf16 v[60:75], v[156:159], v[124:131], v172
    s_waitcnt lgkmcnt(0)
    v_exp_f32 v134, v134
    v_exp_f32 v135, v135
    v_exp_f32 v136, v136
    buffer_load_dwordx4 v0, s[4:7], s94 offen offset:3072 sc1 lds
    v_exp_f32 v137, v137
    v_exp_f32 v138, v138
    v_exp_f32 v139, v139
    v_exp_f32 v108, v108
    v_exp_f32_e64 v109, v109
    v_smfmac_f32_32x32x32_bf16 v[60:75], v[164:167], v[132:139], v172
    v_exp_f32 v110, v110
    v_exp_f32 v111, v111
    v_exp_f32 v112, v112
    v_exp_f32 v113, v113
    v_mfma_f32_32x32x16_bf16 v[124:139], v[152:155], v[144:147], v[92:107]
    s_add_u32 m0, s95, 98304
    s_xor_b32 s94, s54, 98304
    buffer_load_dwordx4 v0, s[4:7], s94 offen offset:0 sc1 lds
    ds_read_b128 v[152:155], v173 offset:19456
    v_exp_f32 v114, v114
    v_exp_f32 v115, v115
    ds_read_b128 v[156:159], v174 offset:2048
    v_exp_f32 v116, v116
    v_exp_f32 v117, v117
    v_smfmac_f32_32x32x32_bf16 v[44:59], v[160:163], v[108:115], v172
    ds_read_b128 v[164:167], v174 offset:2560
    v_exp_f32 v118, v118
    v_exp_f32 v119, v119
    v_exp_f32_e64 v120, v120
    buffer_load_dwordx4 v0, s[4:7], s94 offen offset:1024 sc1 lds
    v_exp_f32 v121, v121
    v_exp_f32 v122, v122
    v_exp_f32 v123, v123
    v_exp_f32 v124, v124
    v_exp_f32_e64 v125, v125
    v_smfmac_f32_32x32x32_bf16 v[44:59], v[168:171], v[116:123], v172
    v_exp_f32 v126, v126
    v_exp_f32 v127, v127
    v_exp_f32 v128, v128
    v_exp_f32 v129, v129
    v_mfma_f32_32x32x16_bf16 v[108:123], v[148:151], v[140:143], v[76:91]
    v_exp_f32 v130, v130
    v_exp_f32 v131, v131
    buffer_load_dwordx4 v0, s[4:7], s94 offen offset:2048 sc1 lds
    v_exp_f32 v132, v132
    v_exp_f32 v133, v133
    v_smfmac_f32_32x32x32_bf16 v[60:75], v[160:163], v[124:131], v172
    s_waitcnt lgkmcnt(0)
    v_exp_f32 v134, v134
    v_exp_f32 v135, v135
    v_exp_f32 v136, v136
    buffer_load_dwordx4 v0, s[4:7], s94 offen offset:3072 sc1 lds
    v_exp_f32 v137, v137
    v_exp_f32 v138, v138
    v_exp_f32 v139, v139
    v_exp_f32 v108, v108
    v_exp_f32_e64 v109, v109
    v_smfmac_f32_32x32x32_bf16 v[60:75], v[168:171], v[132:139], v172
    v_exp_f32 v110, v110
    v_exp_f32 v111, v111
    v_exp_f32 v112, v112
    v_exp_f32 v113, v113
    v_mfma_f32_32x32x16_bf16 v[124:139], v[148:151], v[144:147], v[92:107]
    s_add_u32 m0, s95, 114688
    s_xor_b32 s94, s54, 114688
    buffer_load_dwordx4 v0, s[4:7], s94 offen offset:0 sc1 lds
    ds_read_b128 v[148:151], v173 offset:24576
    v_exp_f32 v114, v114
    v_exp_f32 v115, v115
    ds_read_b128 v[160:163], v174 offset:3072
    v_exp_f32 v116, v116
    v_exp_f32 v117, v117
    v_smfmac_f32_32x32x32_bf16 v[44:59], v[156:159], v[108:115], v172
    ds_read_b128 v[168:171], v174 offset:3584
    v_exp_f32 v118, v118
    v_exp_f32 v119, v119
    v_exp_f32_e64 v120, v120
    buffer_load_dwordx4 v0, s[4:7], s94 offen offset:1024 sc1 lds
    v_exp_f32 v121, v121
    v_exp_f32 v122, v122
    v_exp_f32 v123, v123
    v_exp_f32 v124, v124
    v_exp_f32_e64 v125, v125
    v_smfmac_f32_32x32x32_bf16 v[44:59], v[164:167], v[116:123], v172
    v_exp_f32 v126, v126
    v_exp_f32 v127, v127
    v_exp_f32 v128, v128
    v_exp_f32 v129, v129
    v_mfma_f32_32x32x16_bf16 v[108:123], v[152:155], v[140:143], v[76:91]
    v_exp_f32 v130, v130
    v_exp_f32 v131, v131
    buffer_load_dwordx4 v0, s[4:7], s94 offen offset:2048 sc1 lds
    v_exp_f32 v132, v132
    v_exp_f32 v133, v133
    v_smfmac_f32_32x32x32_bf16 v[60:75], v[156:159], v[124:131], v172
    s_waitcnt lgkmcnt(0)
    v_exp_f32 v134, v134
    v_exp_f32 v135, v135
    v_exp_f32 v136, v136
    buffer_load_dwordx4 v0, s[4:7], s94 offen offset:3072 sc1 lds
    v_exp_f32 v137, v137
    v_exp_f32 v138, v138
    v_exp_f32 v139, v139
    v_exp_f32 v108, v108
    v_exp_f32_e64 v109, v109
    v_smfmac_f32_32x32x32_bf16 v[60:75], v[164:167], v[132:139], v172
    v_exp_f32 v110, v110
    v_exp_f32 v111, v111
    v_exp_f32 v112, v112
    v_exp_f32 v113, v113
    v_mfma_f32_32x32x16_bf16 v[124:139], v[152:155], v[144:147], v[92:107]
    ds_read_b128 v[152:155], v173 offset:25600
    v_add_u32 v174, v175, v174
    v_exp_f32 v114, v114
    v_exp_f32_e64 v115, v115
    ds_read_b128 v[156:159], v174 offset:0
    v_exp_f32 v116, v116
    v_exp_f32 v117, v117
    v_smfmac_f32_32x32x32_bf16 v[44:59], v[160:163], v[108:115], v172
    ds_read_b128 v[164:167], v174 offset:512
    v_exp_f32 v118, v118
    v_exp_f32 v119, v119
    v_exp_f32 v120, v120
    v_exp_f32 v121, v121
    v_exp_f32 v122, v122
    v_exp_f32 v123, v123
    v_exp_f32 v124, v124
    v_exp_f32 v125, v125
    v_smfmac_f32_32x32x32_bf16 v[44:59], v[168:171], v[116:123], v172
    v_exp_f32 v126, v126
    v_exp_f32 v127, v127
    v_exp_f32 v128, v128
    v_exp_f32 v129, v129
    v_mfma_f32_32x32x16_bf16 v[108:123], v[148:151], v[140:143], v[76:91]
    v_exp_f32 v130, v130
    v_exp_f32 v131, v131
    v_exp_f32 v132, v132
    v_exp_f32 v133, v133
    v_smfmac_f32_32x32x32_bf16 v[60:75], v[160:163], v[124:131], v172
    s_waitcnt lgkmcnt(0)
    v_exp_f32 v134, v134
    v_exp_f32 v135, v135
    v_exp_f32 v136, v136
    v_exp_f32 v137, v137
    v_exp_f32 v138, v138
    v_exp_f32 v139, v139
    v_exp_f32 v108, v108
    v_exp_f32_e64 v109, v109
    v_smfmac_f32_32x32x32_bf16 v[60:75], v[168:171], v[132:139], v172
    v_exp_f32 v110, v110
    v_exp_f32 v111, v111
    v_exp_f32 v112, v112
    v_exp_f32 v113, v113
    v_mfma_f32_32x32x16_bf16 v[124:139], v[148:151], v[144:147], v[92:107]
    ds_read_b128 v[148:151], v173 offset:26624
    v_exp_f32 v114, v114
    v_exp_f32 v115, v115
    ds_read_b128 v[160:163], v174 offset:1024
    v_exp_f32 v116, v116
    v_exp_f32 v117, v117
    v_smfmac_f32_32x32x32_bf16 v[44:59], v[156:159], v[108:115], v172
    ds_read_b128 v[168:171], v174 offset:1536
    v_exp_f32 v118, v118
    v_exp_f32 v119, v119
    v_exp_f32 v120, v120
    v_exp_f32 v121, v121
    v_exp_f32 v122, v122
    v_exp_f32 v123, v123
    v_exp_f32 v124, v124
    v_exp_f32 v125, v125
    v_smfmac_f32_32x32x32_bf16 v[44:59], v[164:167], v[116:123], v172
    v_exp_f32 v126, v126
    v_exp_f32 v127, v127
    v_exp_f32 v128, v128
    v_exp_f32 v129, v129
    v_mfma_f32_32x32x16_bf16 v[108:123], v[152:155], v[140:143], v[76:91]
    v_exp_f32 v130, v130
    v_exp_f32 v131, v131
    v_exp_f32 v132, v132
    v_exp_f32 v133, v133
    v_smfmac_f32_32x32x32_bf16 v[60:75], v[156:159], v[124:131], v172
    s_waitcnt lgkmcnt(0)
    v_exp_f32 v134, v134
    v_exp_f32 v135, v135
    v_exp_f32 v136, v136
    v_exp_f32 v137, v137
    v_exp_f32 v138, v138
    v_exp_f32 v139, v139
    v_exp_f32 v108, v108
    v_exp_f32_e64 v109, v109
    v_smfmac_f32_32x32x32_bf16 v[60:75], v[164:167], v[132:139], v172
    v_exp_f32 v110, v110
    v_exp_f32 v111, v111
    v_exp_f32 v112, v112
    v_exp_f32 v113, v113
    v_mfma_f32_32x32x16_bf16 v[124:139], v[152:155], v[144:147], v[92:107]
    ds_read_b128 v[152:155], v173 offset:27648
    v_exp_f32 v114, v114
    v_exp_f32 v115, v115
    ds_read_b128 v[156:159], v174 offset:2048
    v_exp_f32 v116, v116
    v_exp_f32 v117, v117
    v_smfmac_f32_32x32x32_bf16 v[44:59], v[160:163], v[108:115], v172
    ds_read_b128 v[164:167], v174 offset:2560
    v_exp_f32 v118, v118
    v_exp_f32 v119, v119
    v_exp_f32 v120, v120
    v_exp_f32 v121, v121
    v_exp_f32 v122, v122
    v_exp_f32 v123, v123
    v_exp_f32 v124, v124
    v_exp_f32 v125, v125
    v_smfmac_f32_32x32x32_bf16 v[44:59], v[168:171], v[116:123], v172
    v_exp_f32 v126, v126
    v_exp_f32 v127, v127
    v_exp_f32 v128, v128
    v_exp_f32 v129, v129
    v_mfma_f32_32x32x16_bf16 v[108:123], v[148:151], v[140:143], v[76:91]
    v_exp_f32 v130, v130
    v_exp_f32 v131, v131
    v_exp_f32 v132, v132
    v_exp_f32 v133, v133
    v_smfmac_f32_32x32x32_bf16 v[60:75], v[160:163], v[124:131], v172
    s_waitcnt lgkmcnt(0)
    v_exp_f32 v134, v134
    v_exp_f32 v135, v135
    v_exp_f32 v136, v136
    v_exp_f32 v137, v137
    v_exp_f32 v138, v138
    v_exp_f32 v139, v139
    v_exp_f32 v108, v108
    v_exp_f32_e64 v109, v109
    v_smfmac_f32_32x32x32_bf16 v[60:75], v[168:171], v[132:139], v172
    v_exp_f32 v110, v110
    v_exp_f32 v111, v111
    v_exp_f32 v112, v112
    v_exp_f32 v113, v113
    v_mfma_f32_32x32x16_bf16 v[124:139], v[148:151], v[144:147], v[92:107]
    s_waitcnt vmcnt(0)
    s_barrier
    ds_read_b128 v[148:151], v173 offset:32768
    v_exp_f32 v114, v114
    v_exp_f32 v115, v115
    ds_read_b128 v[160:163], v174 offset:3072
    v_exp_f32 v116, v116
    v_exp_f32 v117, v117
    v_smfmac_f32_32x32x32_bf16 v[44:59], v[156:159], v[108:115], v172
    ds_read_b128 v[168:171], v174 offset:3584
    v_exp_f32 v118, v118
    v_exp_f32 v119, v119
    v_exp_f32 v120, v120
    v_exp_f32 v121, v121
    v_exp_f32 v122, v122
    v_exp_f32 v123, v123
    v_exp_f32 v124, v124
    v_exp_f32 v125, v125
    v_smfmac_f32_32x32x32_bf16 v[44:59], v[164:167], v[116:123], v172
    v_exp_f32 v126, v126
    v_exp_f32 v127, v127
    v_exp_f32 v128, v128
    v_exp_f32 v129, v129
    v_mfma_f32_32x32x16_bf16 v[108:123], v[152:155], v[140:143], v[76:91]
    v_exp_f32 v130, v130
    v_exp_f32 v131, v131
    v_exp_f32 v132, v132
    v_exp_f32 v133, v133
    v_smfmac_f32_32x32x32_bf16 v[60:75], v[156:159], v[124:131], v172
    s_waitcnt lgkmcnt(0)
    v_exp_f32 v134, v134
    v_exp_f32 v135, v135
    v_exp_f32 v136, v136
    v_exp_f32 v137, v137
    v_exp_f32 v138, v138
    v_exp_f32 v139, v139
    v_exp_f32 v108, v108
    v_exp_f32_e64 v109, v109
    v_smfmac_f32_32x32x32_bf16 v[60:75], v[164:167], v[132:139], v172
    v_exp_f32 v110, v110
    v_exp_f32 v111, v111
    v_exp_f32 v112, v112
    v_exp_f32 v113, v113
    v_mfma_f32_32x32x16_bf16 v[124:139], v[152:155], v[144:147], v[92:107]
    ds_read_b128 v[152:155], v173 offset:33792
    v_add_u32 v174, v175, v174
    v_exp_f32 v114, v114
    v_exp_f32_e64 v115, v115
    ds_read_b128 v[156:159], v174 offset:0
    v_exp_f32 v116, v116
    v_exp_f32 v117, v117
    v_smfmac_f32_32x32x32_bf16 v[44:59], v[160:163], v[108:115], v172
    ds_read_b128 v[164:167], v174 offset:512
    v_exp_f32 v118, v118
    v_exp_f32 v119, v119
    v_exp_f32_e64 v120, v120
    buffer_load_dwordx4 v[252:255], v0, s[4:7], s96 offen sc1
    v_exp_f32 v121, v121
    v_exp_f32 v122, v122
    v_exp_f32 v123, v123
    v_exp_f32 v124, v124
    v_exp_f32_e64 v125, v125
    v_smfmac_f32_32x32x32_bf16 v[44:59], v[168:171], v[116:123], v172
    v_exp_f32 v126, v126
    v_exp_f32 v127, v127
    v_exp_f32 v128, v128
    v_exp_f32 v129, v129
    v_mfma_f32_32x32x16_bf16 v[108:123], v[148:151], v[140:143], v[76:91]
    v_exp_f32 v130, v130
    v_exp_f32 v131, v131
    v_exp_f32 v132, v132
    v_exp_f32 v133, v133
    v_smfmac_f32_32x32x32_bf16 v[60:75], v[160:163], v[124:131], v172
    s_waitcnt lgkmcnt(0)
    v_exp_f32 v134, v134
    v_exp_f32 v135, v135
    v_exp_f32 v136, v136
    v_exp_f32 v137, v137
    v_exp_f32 v138, v138
    v_exp_f32 v139, v139
    v_exp_f32 v108, v108
    v_exp_f32_e64 v109, v109
    v_smfmac_f32_32x32x32_bf16 v[60:75], v[168:171], v[132:139], v172
    v_exp_f32 v110, v110
    v_exp_f32 v111, v111
    v_exp_f32 v112, v112
    v_exp_f32 v113, v113
    v_mfma_f32_32x32x16_bf16 v[124:139], v[148:151], v[144:147], v[92:107]
    ds_read_b128 v[148:151], v173 offset:34816
    v_exp_f32 v114, v114
    v_exp_f32 v115, v115
    ds_read_b128 v[160:163], v174 offset:1024
    v_exp_f32 v116, v116
    v_exp_f32 v117, v117
    v_smfmac_f32_32x32x32_bf16 v[44:59], v[156:159], v[108:115], v172
    ds_read_b128 v[168:171], v174 offset:1536
    v_exp_f32 v118, v118
    v_exp_f32 v119, v119
    v_exp_f32 v120, v120
    v_exp_f32 v121, v121
    v_exp_f32 v122, v122
    v_exp_f32 v123, v123
    v_exp_f32 v124, v124
    v_exp_f32 v125, v125
    v_smfmac_f32_32x32x32_bf16 v[44:59], v[164:167], v[116:123], v172
    v_exp_f32 v126, v126
    v_exp_f32 v127, v127
    v_exp_f32 v128, v128
    v_exp_f32 v129, v129
    v_mfma_f32_32x32x16_bf16 v[108:123], v[152:155], v[140:143], v[76:91]
    v_exp_f32 v130, v130
    v_exp_f32 v131, v131
    v_exp_f32 v132, v132
    v_exp_f32 v133, v133
    v_smfmac_f32_32x32x32_bf16 v[60:75], v[156:159], v[124:131], v172
    s_waitcnt lgkmcnt(0)
    v_exp_f32 v134, v134
    v_exp_f32 v135, v135
    v_exp_f32 v136, v136
    v_exp_f32 v137, v137
    v_exp_f32 v138, v138
    v_exp_f32 v139, v139
    v_exp_f32 v108, v108
    v_exp_f32_e64 v109, v109
    v_smfmac_f32_32x32x32_bf16 v[60:75], v[164:167], v[132:139], v172
    v_exp_f32 v110, v110
    v_exp_f32 v111, v111
    v_exp_f32 v112, v112
    v_exp_f32 v113, v113
    v_mfma_f32_32x32x16_bf16 v[124:139], v[152:155], v[144:147], v[92:107]
    ds_read_b128 v[152:155], v173 offset:35840
    v_exp_f32 v114, v114
    v_exp_f32 v115, v115
    ds_read_b128 v[156:159], v174 offset:2048
    v_exp_f32 v116, v116
    v_exp_f32 v117, v117
    v_smfmac_f32_32x32x32_bf16 v[44:59], v[160:163], v[108:115], v172
    ds_read_b128 v[164:167], v174 offset:2560
    v_exp_f32 v118, v118
    v_exp_f32 v119, v119
    v_exp_f32 v120, v120
    s_waitcnt vmcnt(0)
    v_xor_b32 v252, s23, v252
    v_xor_b32 v253, s23, v253
    v_xor_b32 v254, s23, v254
    v_xor_b32 v255, s23, v255
    v_or3_b32 v252, v252, v253, v254
    v_or_b32 v252, v252, v255
    v_cmp_lt_u32 vcc, 7, v252
    s_cbranch_vccnz L_spin_8
L_back_9:
    v_exp_f32 v121, v121
    v_exp_f32 v122, v122
    v_exp_f32 v123, v123
    v_exp_f32 v124, v124
    v_exp_f32 v125, v125
    v_smfmac_f32_32x32x32_bf16 v[44:59], v[168:171], v[116:123], v172
    v_exp_f32 v126, v126
    v_exp_f32 v127, v127
    v_exp_f32 v128, v128
    v_exp_f32 v129, v129
    v_mfma_f32_32x32x16_bf16 v[108:123], v[148:151], v[140:143], v[76:91]
    v_exp_f32 v130, v130
    v_exp_f32 v131, v131
    v_exp_f32 v132, v132
    v_exp_f32 v133, v133
    v_smfmac_f32_32x32x32_bf16 v[60:75], v[160:163], v[124:131], v172
    s_waitcnt lgkmcnt(0)
    v_exp_f32 v134, v134
    v_exp_f32 v135, v135
    v_exp_f32 v136, v136
    v_exp_f32 v137, v137
    v_exp_f32 v138, v138
    v_exp_f32 v139, v139
    v_exp_f32 v108, v108
    v_exp_f32_e64 v109, v109
    v_smfmac_f32_32x32x32_bf16 v[60:75], v[168:171], v[132:139], v172
    v_exp_f32 v110, v110
    v_exp_f32 v111, v111
    v_exp_f32 v112, v112
    v_exp_f32 v113, v113
    v_mfma_f32_32x32x16_bf16 v[124:139], v[148:151], v[144:147], v[92:107]
    ds_read_b128 v[148:151], v173 offset:40960
    v_exp_f32 v114, v114
    v_exp_f32 v115, v115
    ds_read_b128 v[160:163], v174 offset:3072
    v_exp_f32 v116, v116
    v_exp_f32 v117, v117
    v_smfmac_f32_32x32x32_bf16 v[44:59], v[156:159], v[108:115], v172
    ds_read_b128 v[168:171], v174 offset:3584
    v_exp_f32 v118, v118
    v_exp_f32 v119, v119
    v_exp_f32_e64 v120, v120
    buffer_load_dwordx4 v[180:183], v0, s[4:7], s57 offen offset:0 sc1
    v_exp_f32 v121, v121
    v_exp_f32 v122, v122
    v_exp_f32 v123, v123
    v_exp_f32 v124, v124
    v_exp_f32_e64 v125, v125
    v_smfmac_f32_32x32x32_bf16 v[44:59], v[164:167], v[116:123], v172
    v_exp_f32 v126, v126
    v_exp_f32 v127, v127
    v_exp_f32 v128, v128
    v_exp_f32 v129, v129
    v_mfma_f32_32x32x16_bf16 v[108:123], v[152:155], v[140:143], v[76:91]
    v_exp_f32 v130, v130
    v_exp_f32 v131, v131
    v_exp_f32 v132, v132
    v_exp_f32 v133, v133
    v_smfmac_f32_32x32x32_bf16 v[60:75], v[156:159], v[124:131], v172
    s_waitcnt lgkmcnt(0)
    v_exp_f32 v134, v134
    v_exp_f32 v135, v135
    v_exp_f32 v136, v136
    buffer_load_dwordx4 v[184:187], v0, s[4:7], s58 offen offset:0 sc1
    v_exp_f32 v137, v137
    v_exp_f32 v138, v138
    v_exp_f32 v139, v139
    v_exp_f32 v108, v108
    v_exp_f32_e64 v109, v109
    v_smfmac_f32_32x32x32_bf16 v[60:75], v[164:167], v[132:139], v172
    v_exp_f32 v110, v110
    v_exp_f32 v111, v111
    v_exp_f32 v112, v112
    v_exp_f32 v113, v113
    v_mfma_f32_32x32x16_bf16 v[124:139], v[152:155], v[144:147], v[92:107]
    ds_read_b128 v[152:155], v173 offset:41984
    v_add_u32 v174, v175, v174
    v_exp_f32 v114, v114
    v_exp_f32_e64 v115, v115
    ds_read_b128 v[156:159], v174 offset:0
    v_exp_f32 v116, v116
    v_exp_f32 v117, v117
    v_smfmac_f32_32x32x32_bf16 v[44:59], v[160:163], v[108:115], v172
    ds_read_b128 v[164:167], v174 offset:512
    v_exp_f32 v118, v118
    v_exp_f32 v119, v119
    v_exp_f32_e64 v120, v120
    buffer_load_dwordx4 v[188:191], v0, s[4:7], s57 offen offset:1024 sc1
    v_exp_f32 v121, v121
    v_exp_f32 v122, v122
    v_exp_f32 v123, v123
    v_exp_f32 v124, v124
    v_exp_f32_e64 v125, v125
    v_smfmac_f32_32x32x32_bf16 v[44:59], v[168:171], v[116:123], v172
    v_exp_f32 v126, v126
    v_exp_f32 v127, v127
    v_exp_f32 v128, v128
    v_exp_f32 v129, v129
    v_mfma_f32_32x32x16_bf16 v[108:123], v[148:151], v[140:143], v[76:91]
    v_exp_f32 v130, v130
    v_exp_f32 v131, v131
    v_exp_f32 v132, v132
    v_exp_f32 v133, v133
    v_smfmac_f32_32x32x32_bf16 v[60:75], v[160:163], v[124:131], v172
    s_waitcnt lgkmcnt(0)
    v_exp_f32 v134, v134
    v_exp_f32 v135, v135
    v_exp_f32 v136, v136
    buffer_load_dwordx4 v[192:195], v0, s[4:7], s58 offen offset:1024 sc1
    v_exp_f32 v137, v137
    v_exp_f32 v138, v138
    v_exp_f32 v139, v139
    v_exp_f32 v108, v108
    v_exp_f32_e64 v109, v109
    v_smfmac_f32_32x32x32_bf16 v[60:75], v[168:171], v[132:139], v172
    v_exp_f32 v110, v110
    v_exp_f32 v111, v111
    v_exp_f32 v112, v112
    v_exp_f32 v113, v113
    v_mfma_f32_32x32x16_bf16 v[124:139], v[148:151], v[144:147], v[92:107]
    ds_read_b128 v[148:151], v173 offset:43008
    v_exp_f32 v114, v114
    v_exp_f32 v115, v115
    ds_read_b128 v[160:163], v174 offset:1024
    v_exp_f32 v116, v116
    v_exp_f32 v117, v117
    v_smfmac_f32_32x32x32_bf16 v[44:59], v[156:159], v[108:115], v172
    ds_read_b128 v[168:171], v174 offset:1536
    v_exp_f32 v118, v118
    v_exp_f32 v119, v119
    v_exp_f32_e64 v120, v120
    buffer_load_dwordx4 v[196:199], v0, s[4:7], s57 offen offset:2048 sc1
    v_exp_f32 v121, v121
    v_exp_f32 v122, v122
    v_exp_f32 v123, v123
    v_exp_f32 v124, v124
    v_exp_f32_e64 v125, v125
    v_smfmac_f32_32x32x32_bf16 v[44:59], v[164:167], v[116:123], v172
    v_exp_f32 v126, v126
    v_exp_f32 v127, v127
    v_exp_f32 v128, v128
    v_exp_f32 v129, v129
    v_mfma_f32_32x32x16_bf16 v[108:123], v[152:155], v[140:143], v[76:91]
    v_exp_f32 v130, v130
    v_exp_f32 v131, v131
    s_add_u32 s94, s49, 2097152
    buffer_store_dwordx4 v[8:11], v29, s[4:7], s94 offen offset:0 sc1
    v_exp_f32 v132, v132
    v_exp_f32 v133, v133
    v_smfmac_f32_32x32x32_bf16 v[60:75], v[156:159], v[124:131], v172
    s_waitcnt lgkmcnt(0)
    v_exp_f32 v134, v134
    v_exp_f32 v135, v135
    v_exp_f32 v136, v136
    buffer_load_dwordx4 v[200:203], v0, s[4:7], s58 offen offset:2048 sc1
    v_exp_f32 v137, v137
    v_exp_f32 v138, v138
    v_exp_f32 v139, v139
    v_exp_f32 v108, v108
    v_exp_f32_e64 v109, v109
    v_smfmac_f32_32x32x32_bf16 v[60:75], v[164:167], v[132:139], v172
    v_exp_f32 v110, v110
    v_exp_f32 v111, v111
    v_exp_f32 v112, v112
    v_exp_f32 v113, v113
    v_mfma_f32_32x32x16_bf16 v[124:139], v[152:155], v[144:147], v[92:107]
    ds_read_b128 v[152:155], v173 offset:44032
    v_exp_f32 v114, v114
    v_exp_f32 v115, v115
    ds_read_b128 v[156:159], v174 offset:2048
    v_exp_f32 v116, v116
    v_exp_f32 v117, v117
    v_smfmac_f32_32x32x32_bf16 v[44:59], v[160:163], v[108:115], v172
    ds_read_b128 v[164:167], v174 offset:2560
    v_exp_f32 v118, v118
    v_exp_f32 v119, v119
    v_exp_f32_e64 v120, v120
    buffer_load_dwordx4 v[204:207], v0, s[4:7], s57 offen offset:3072 sc1
    v_exp_f32 v121, v121
    v_exp_f32 v122, v122
    v_exp_f32 v123, v123
    v_exp_f32 v124, v124
    v_exp_f32_e64 v125, v125
    v_smfmac_f32_32x32x32_bf16 v[44:59], v[168:171], v[116:123], v172
    v_exp_f32 v126, v126
    v_exp_f32 v127, v127
    v_exp_f32 v128, v128
    v_exp_f32 v129, v129
    v_mfma_f32_32x32x16_bf16 v[108:123], v[148:151], v[140:143], v[76:91]
    v_exp_f32 v130, v130
    v_exp_f32 v131, v131
    v_exp_f32 v132, v132
    v_exp_f32 v133, v133
    v_smfmac_f32_32x32x32_bf16 v[60:75], v[160:163], v[124:131], v172
    s_waitcnt lgkmcnt(0)
    v_exp_f32 v134, v134
    v_exp_f32 v135, v135
    v_exp_f32 v136, v136
    buffer_load_dwordx4 v[208:211], v0, s[4:7], s58 offen offset:3072 sc1
    v_exp_f32 v137, v137
    v_exp_f32 v138, v138
    v_exp_f32 v139, v139
    v_exp_f32 v108, v108
    v_exp_f32_e64 v109, v109
    v_smfmac_f32_32x32x32_bf16 v[60:75], v[168:171], v[132:139], v172
    v_exp_f32 v110, v110
    v_exp_f32 v111, v111
    v_exp_f32 v112, v112
    v_exp_f32 v113, v113
    v_mfma_f32_32x32x16_bf16 v[124:139], v[148:151], v[144:147], v[92:107]
    ds_read_b128 v[148:151], v173 offset:49152
    v_exp_f32 v114, v114
    v_exp_f32 v115, v115
    ds_read_b128 v[160:163], v174 offset:3072
    v_exp_f32 v116, v116
    v_exp_f32 v117, v117
    v_smfmac_f32_32x32x32_bf16 v[44:59], v[156:159], v[108:115], v172
    ds_read_b128 v[168:171], v174 offset:3584
    v_exp_f32 v118, v118
    v_exp_f32 v119, v119
    v_exp_f32_e64 v120, v120
    buffer_load_dwordx4 v[212:215], v5, s[4:7], s57 offen offset:0 sc1
    v_exp_f32 v121, v121
    v_exp_f32 v122, v122
    v_exp_f32 v123, v123
    v_exp_f32 v124, v124
    v_exp_f32_e64 v125, v125
    v_smfmac_f32_32x32x32_bf16 v[44:59], v[164:167], v[116:123], v172
    v_exp_f32 v126, v126
    v_exp_f32 v127, v127
    v_exp_f32 v128, v128
    v_exp_f32 v129, v129
    v_mfma_f32_32x32x16_bf16 v[108:123], v[152:155], v[140:143], v[76:91]
    v_exp_f32 v130, v130
    v_exp_f32 v131, v131
    s_add_u32 s94, s49, 2097152
    buffer_store_dwordx4 v[8:11], v29, s[4:7], s94 offen offset:1024 sc1
    v_exp_f32 v132, v132
    v_exp_f32 v133, v133
    v_smfmac_f32_32x32x32_bf16 v[60:75], v[156:159], v[124:131], v172
    s_waitcnt lgkmcnt(0)
    v_exp_f32 v134, v134
    v_exp_f32 v135, v135
    v_exp_f32 v136, v136
    buffer_load_dwordx4 v[216:219], v5, s[4:7], s58 offen offset:0 sc1
    v_exp_f32 v137, v137
    v_exp_f32 v138, v138
    v_exp_f32 v139, v139
    v_exp_f32 v108, v108
    v_exp_f32_e64 v109, v109
    v_smfmac_f32_32x32x32_bf16 v[60:75], v[164:167], v[132:139], v172
    v_exp_f32 v110, v110
    v_exp_f32 v111, v111
    v_exp_f32 v112, v112
    v_exp_f32 v113, v113
    v_mfma_f32_32x32x16_bf16 v[124:139], v[152:155], v[144:147], v[92:107]
    ds_read_b128 v[152:155], v173 offset:50176
    v_add_u32 v174, v175, v174
    v_exp_f32 v114, v114
    v_exp_f32_e64 v115, v115
    ds_read_b128 v[156:159], v174 offset:0
    v_exp_f32 v116, v116
    v_exp_f32 v117, v117
    v_smfmac_f32_32x32x32_bf16 v[44:59], v[160:163], v[108:115], v172
    ds_read_b128 v[164:167], v174 offset:512
    v_exp_f32 v118, v118
    v_exp_f32 v119, v119
    v_exp_f32_e64 v120, v120
    buffer_load_dwordx4 v[220:223], v5, s[4:7], s57 offen offset:1024 sc1
    v_exp_f32 v121, v121
    v_exp_f32 v122, v122
    v_exp_f32 v123, v123
    v_exp_f32 v124, v124
    v_exp_f32_e64 v125, v125
    v_smfmac_f32_32x32x32_bf16 v[44:59], v[168:171], v[116:123], v172
    v_exp_f32 v126, v126
    v_exp_f32 v127, v127
    v_exp_f32 v128, v128
    v_exp_f32 v129, v129
    v_mfma_f32_32x32x16_bf16 v[108:123], v[148:151], v[140:143], v[76:91]
    v_exp_f32 v130, v130
    v_exp_f32 v131, v131
    v_exp_f32 v132, v132
    v_exp_f32 v133, v133
    v_smfmac_f32_32x32x32_bf16 v[60:75], v[160:163], v[124:131], v172
    s_waitcnt lgkmcnt(0)
    v_exp_f32 v134, v134
    v_exp_f32 v135, v135
    v_exp_f32 v136, v136
    buffer_load_dwordx4 v[224:227], v5, s[4:7], s58 offen offset:1024 sc1
    v_exp_f32 v137, v137
    v_exp_f32 v138, v138
    v_exp_f32 v139, v139
    v_exp_f32 v108, v108
    v_exp_f32_e64 v109, v109
    v_smfmac_f32_32x32x32_bf16 v[60:75], v[168:171], v[132:139], v172
    v_exp_f32 v110, v110
    v_exp_f32 v111, v111
    v_exp_f32 v112, v112
    v_exp_f32 v113, v113
    v_mfma_f32_32x32x16_bf16 v[124:139], v[148:151], v[144:147], v[92:107]
    ds_read_b128 v[148:151], v173 offset:51200
    v_exp_f32 v114, v114
    v_exp_f32 v115, v115
    ds_read_b128 v[160:163], v174 offset:1024
    v_exp_f32 v116, v116
    v_exp_f32 v117, v117
    v_smfmac_f32_32x32x32_bf16 v[44:59], v[156:159], v[108:115], v172
    ds_read_b128 v[168:171], v174 offset:1536
    v_exp_f32 v118, v118
    v_exp_f32 v119, v119
    v_exp_f32_e64 v120, v120
    buffer_load_dwordx4 v[228:231], v5, s[4:7], s57 offen offset:2048 sc1
    v_exp_f32 v121, v121
    v_exp_f32 v122, v122
    v_exp_f32 v123, v123
    v_exp_f32 v124, v124
    v_exp_f32_e64 v125, v125
    v_smfmac_f32_32x32x32_bf16 v[44:59], v[164:167], v[116:123], v172
    v_exp_f32 v126, v126
    v_exp_f32 v127, v127
    v_exp_f32 v128, v128
    v_exp_f32 v129, v129
    v_mfma_f32_32x32x16_bf16 v[108:123], v[152:155], v[140:143], v[76:91]
    v_exp_f32 v130, v130
    v_exp_f32 v131, v131
    buffer_store_dwordx4 v[8:11], v29, s[4:7], s49 offen offset:0 sc1
    v_exp_f32 v132, v132
    v_exp_f32 v133, v133
    v_smfmac_f32_32x32x32_bf16 v[60:75], v[156:159], v[124:131], v172
    s_waitcnt lgkmcnt(0)
    v_exp_f32 v134, v134
    v_exp_f32 v135, v135
    v_exp_f32 v136, v136
    buffer_load_dwordx4 v[232:235], v5, s[4:7], s58 offen offset:2048 sc1
    v_exp_f32 v137, v137
    v_exp_f32 v138, v138
    v_exp_f32 v139, v139
    v_exp_f32 v108, v108
    v_exp_f32_e64 v109, v109
    v_smfmac_f32_32x32x32_bf16 v[60:75], v[164:167], v[132:139], v172
    v_exp_f32 v110, v110
    v_exp_f32 v111, v111
    v_exp_f32 v112, v112
    v_exp_f32 v113, v113
    v_mfma_f32_32x32x16_bf16 v[124:139], v[152:155], v[144:147], v[92:107]
    ds_read_b128 v[152:155], v173 offset:52224
    v_exp_f32 v114, v114
    v_exp_f32 v115, v115
    ds_read_b128 v[156:159], v174 offset:2048
    v_exp_f32 v116, v116
    v_exp_f32 v117, v117
    v_smfmac_f32_32x32x32_bf16 v[44:59], v[160:163], v[108:115], v172
    ds_read_b128 v[164:167], v174 offset:2560
    v_exp_f32 v118, v118
    v_exp_f32 v119, v119
    v_exp_f32_e64 v120, v120
    buffer_load_dwordx4 v[236:239], v5, s[4:7], s57 offen offset:3072 sc1
    v_exp_f32 v121, v121
    v_exp_f32 v122, v122
    v_exp_f32 v123, v123
    v_exp_f32 v124, v124
    v_exp_f32_e64 v125, v125
    v_smfmac_f32_32x32x32_bf16 v[44:59], v[168:171], v[116:123], v172
    v_exp_f32 v126, v126
    v_exp_f32 v127, v127
    v_exp_f32 v128, v128
    v_exp_f32 v129, v129
    v_mfma_f32_32x32x16_bf16 v[108:123], v[148:151], v[140:143], v[76:91]
    v_exp_f32 v130, v130
    v_exp_f32 v131, v131
    v_exp_f32 v132, v132
    v_exp_f32 v133, v133
    v_smfmac_f32_32x32x32_bf16 v[60:75], v[160:163], v[124:131], v172
    s_waitcnt lgkmcnt(0)
    v_exp_f32 v134, v134
    v_exp_f32 v135, v135
    v_exp_f32 v136, v136
    buffer_load_dwordx4 v[240:243], v5, s[4:7], s58 offen offset:3072 sc1
    v_exp_f32 v137, v137
    v_exp_f32 v138, v138
    v_exp_f32 v139, v139
    v_exp_f32 v108, v108
    v_exp_f32_e64 v109, v109
    v_smfmac_f32_32x32x32_bf16 v[60:75], v[168:171], v[132:139], v172
    v_exp_f32 v110, v110
    v_exp_f32 v111, v111
    v_exp_f32 v112, v112
    v_exp_f32 v113, v113
    v_mfma_f32_32x32x16_bf16 v[124:139], v[148:151], v[144:147], v[92:107]
    ds_read_b128 v[148:151], v173 offset:57344
    v_exp_f32 v114, v114
    v_exp_f32 v115, v115
    ds_read_b128 v[160:163], v174 offset:3072
    v_exp_f32 v116, v116
    v_exp_f32 v117, v117
    v_smfmac_f32_32x32x32_bf16 v[44:59], v[156:159], v[108:115], v172
    ds_read_b128 v[168:171], v174 offset:3584
    v_exp_f32 v118, v118
    v_exp_f32 v119, v119
    v_exp_f32_e64 v120, v120
    buffer_load_dwordx4 a[0:3], v0, s[4:7], s59 offen offset:0 sc1
    v_exp_f32 v121, v121
    v_exp_f32 v122, v122
    v_exp_f32 v123, v123
    v_exp_f32 v124, v124
    v_exp_f32_e64 v125, v125
    v_smfmac_f32_32x32x32_bf16 v[44:59], v[164:167], v[116:123], v172
    v_exp_f32 v126, v126
    v_exp_f32 v127, v127
    v_exp_f32 v128, v128
    v_exp_f32 v129, v129
    v_mfma_f32_32x32x16_bf16 v[108:123], v[152:155], v[140:143], v[76:91]
    v_exp_f32 v130, v130
    v_exp_f32 v131, v131
    buffer_store_dwordx4 v[8:11], v29, s[4:7], s49 offen offset:1024 sc1
    v_exp_f32 v132, v132
    v_exp_f32 v133, v133
    v_smfmac_f32_32x32x32_bf16 v[60:75], v[156:159], v[124:131], v172
    s_waitcnt lgkmcnt(0)
    v_exp_f32 v134, v134
    v_exp_f32 v135, v135
    v_exp_f32 v136, v136
    buffer_load_dwordx4 a[4:7], v0, s[4:7], s59 offen offset:1024 sc1
    v_exp_f32 v137, v137
    v_exp_f32 v138, v138
    v_exp_f32 v139, v139
    v_exp_f32 v108, v108
    v_exp_f32_e64 v109, v109
    v_smfmac_f32_32x32x32_bf16 v[60:75], v[164:167], v[132:139], v172
    v_exp_f32 v110, v110
    v_exp_f32 v111, v111
    v_exp_f32 v112, v112
    v_exp_f32 v113, v113
    v_mfma_f32_32x32x16_bf16 v[124:139], v[152:155], v[144:147], v[92:107]
    ds_read_b128 v[152:155], v173 offset:58368
    v_add_u32 v174, v175, v174
    v_exp_f32 v114, v114
    v_exp_f32_e64 v115, v115
    ds_read_b128 v[156:159], v174 offset:0
    v_exp_f32 v116, v116
    v_exp_f32 v117, v117
    v_smfmac_f32_32x32x32_bf16 v[44:59], v[160:163], v[108:115], v172
    ds_read_b128 v[164:167], v174 offset:512
    v_exp_f32 v118, v118
    v_exp_f32 v119, v119
    v_exp_f32_e64 v120, v120
    buffer_load_dwordx4 a[8:11], v0, s[4:7], s59 offen offset:2048 sc1
    v_exp_f32 v121, v121
    v_exp_f32 v122, v122
    v_exp_f32 v123, v123
    v_exp_f32 v124, v124
    v_exp_f32_e64 v125, v125
    v_smfmac_f32_32x32x32_bf16 v[44:59], v[168:171], v[116:123], v172
    v_exp_f32 v126, v126
    v_exp_f32 v127, v127
    v_exp_f32 v128, v128
    v_exp_f32 v129, v129
    v_mfma_f32_32x32x16_bf16 v[108:123], v[148:151], v[140:143], v[76:91]
    v_exp_f32 v130, v130
    v_exp_f32 v131, v131
    v_exp_f32 v132, v132
    v_exp_f32 v133, v133
    v_smfmac_f32_32x32x32_bf16 v[60:75], v[160:163], v[124:131], v172
    s_waitcnt lgkmcnt(0)
    v_exp_f32 v134, v134
    v_exp_f32 v135, v135
    v_exp_f32 v136, v136
    buffer_load_dwordx4 a[12:15], v0, s[4:7], s59 offen offset:3072 sc1
    v_exp_f32 v137, v137
    v_exp_f32 v138, v138
    v_exp_f32 v139, v139
    v_exp_f32 v108, v108
    v_exp_f32_e64 v109, v109
    v_smfmac_f32_32x32x32_bf16 v[60:75], v[168:171], v[132:139], v172
    v_exp_f32 v110, v110
    v_exp_f32 v111, v111
    v_exp_f32 v112, v112
    v_exp_f32 v113, v113
    v_mfma_f32_32x32x16_bf16 v[124:139], v[148:151], v[144:147], v[92:107]
    ds_read_b128 v[148:151], v173 offset:59392
    v_exp_f32 v114, v114
    v_exp_f32 v115, v115
    ds_read_b128 v[160:163], v174 offset:1024
    v_exp_f32 v116, v116
    v_exp_f32 v117, v117
    v_smfmac_f32_32x32x32_bf16 v[44:59], v[156:159], v[108:115], v172
    ds_read_b128 v[168:171], v174 offset:1536
    v_exp_f32 v118, v118
    v_exp_f32 v119, v119
    v_exp_f32_e64 v120, v120
    buffer_load_dwordx4 a[16:19], v5, s[4:7], s59 offen offset:0 sc1
    v_exp_f32 v121, v121
    v_exp_f32 v122, v122
    v_exp_f32 v123, v123
    v_exp_f32 v124, v124
    v_exp_f32_e64 v125, v125
    v_smfmac_f32_32x32x32_bf16 v[44:59], v[164:167], v[116:123], v172
    v_exp_f32 v126, v126
    v_exp_f32 v127, v127
    v_exp_f32 v128, v128
    v_exp_f32 v129, v129
    v_mfma_f32_32x32x16_bf16 v[108:123], v[152:155], v[140:143], v[76:91]
    v_exp_f32 v130, v130
    v_exp_f32 v131, v131
    buffer_store_dwordx4 v[8:11], v29, s[4:7], s71 offen offset:0 sc1
    v_exp_f32 v132, v132
    v_exp_f32 v133, v133
    v_smfmac_f32_32x32x32_bf16 v[60:75], v[156:159], v[124:131], v172
    s_waitcnt lgkmcnt(0)
    v_exp_f32 v134, v134
    v_exp_f32 v135, v135
    v_exp_f32 v136, v136
    buffer_load_dwordx4 a[20:23], v5, s[4:7], s59 offen offset:1024 sc1
    v_exp_f32 v137, v137
    v_exp_f32 v138, v138
    v_exp_f32 v139, v139
    v_exp_f32 v108, v108
    v_exp_f32_e64 v109, v109
    v_smfmac_f32_32x32x32_bf16 v[60:75], v[164:167], v[132:139], v172
    v_exp_f32 v110, v110
    v_exp_f32 v111, v111
    v_exp_f32 v112, v112
    v_exp_f32 v113, v113
    v_mfma_f32_32x32x16_bf16 v[124:139], v[152:155], v[144:147], v[92:107]
    ds_read_b128 v[152:155], v173 offset:60416
    v_exp_f32 v114, v114
    v_exp_f32 v115, v115
    ds_read_b128 v[156:159], v174 offset:2048
    v_exp_f32 v116, v116
    v_exp_f32 v117, v117
    v_smfmac_f32_32x32x32_bf16 v[44:59], v[160:163], v[108:115], v172
    ds_read_b128 v[164:167], v174 offset:2560
    v_exp_f32 v118, v118
    v_exp_f32 v119, v119
    v_exp_f32_e64 v120, v120
    buffer_load_dwordx4 a[24:27], v5, s[4:7], s59 offen offset:2048 sc1
    v_exp_f32 v121, v121
    v_exp_f32 v122, v122
    v_exp_f32 v123, v123
    v_exp_f32 v124, v124
    v_exp_f32_e64 v125, v125
    v_smfmac_f32_32x32x32_bf16 v[44:59], v[168:171], v[116:123], v172
    v_exp_f32 v126, v126
    v_exp_f32 v127, v127
    v_exp_f32 v128, v128
    v_exp_f32 v129, v129
    v_mfma_f32_32x32x16_bf16 v[108:123], v[148:151], v[140:143], v[76:91]
    v_exp_f32 v130, v130
    v_exp_f32 v131, v131
    v_exp_f32 v132, v132
    v_exp_f32 v133, v133
    v_smfmac_f32_32x32x32_bf16 v[60:75], v[160:163], v[124:131], v172
    s_waitcnt lgkmcnt(0)
    v_exp_f32 v134, v134
    v_exp_f32 v135, v135
    v_exp_f32 v136, v136
    buffer_load_dwordx4 a[28:31], v5, s[4:7], s59 offen offset:3072 sc1
    v_exp_f32 v137, v137
    v_exp_f32 v138, v138
    v_exp_f32 v139, v139
    v_exp_f32 v108, v108
    v_exp_f32_e64 v109, v109
    v_smfmac_f32_32x32x32_bf16 v[60:75], v[168:171], v[132:139], v172
    v_exp_f32 v110, v110
    v_exp_f32 v111, v111
    v_exp_f32 v112, v112
    v_exp_f32 v113, v113
    v_mfma_f32_32x32x16_bf16 v[124:139], v[148:151], v[144:147], v[92:107]
    v_add_u32 v173, 0x10000, v173
    ds_read_b128 v[148:151], v173 offset:0
    v_exp_f32 v114, v114
    v_exp_f32 v115, v115
    ds_read_b128 v[160:163], v174 offset:3072
    v_exp_f32 v116, v116
    v_exp_f32 v117, v117
    v_smfmac_f32_32x32x32_bf16 v[44:59], v[156:159], v[108:115], v172
    ds_read_b128 v[168:171], v174 offset:3584
    v_exp_f32 v118, v118
    v_exp_f32 v119, v119
    v_exp_f32_e64 v120, v120
    buffer_load_dwordx4 a[32:35], v0, s[4:7], s60 offen offset:0 sc1
    v_exp_f32 v121, v121
    v_exp_f32 v122, v122
    v_exp_f32 v123, v123
    v_exp_f32 v124, v124
    v_exp_f32_e64 v125, v125
    v_smfmac_f32_32x32x32_bf16 v[44:59], v[164:167], v[116:123], v172
    v_exp_f32 v126, v126
    v_exp_f32 v127, v127
    v_exp_f32 v128, v128
    v_exp_f32 v129, v129
    v_mfma_f32_32x32x16_bf16 v[108:123], v[152:155], v[140:143], v[76:91]
    v_exp_f32 v130, v130
    v_exp_f32 v131, v131
    buffer_store_dwordx4 v[8:11], v29, s[4:7], s71 offen offset:1024 sc1
    v_exp_f32 v132, v132
    v_exp_f32 v133, v133
    v_smfmac_f32_32x32x32_bf16 v[60:75], v[156:159], v[124:131], v172
    s_waitcnt lgkmcnt(0)
    v_exp_f32 v134, v134
    v_exp_f32 v135, v135
    v_exp_f32 v136, v136
    buffer_load_dwordx4 a[36:39], v0, s[4:7], s60 offen offset:1024 sc1
    v_exp_f32 v137, v137
    v_exp_f32 v138, v138
    v_exp_f32 v139, v139
    v_exp_f32 v108, v108
    v_exp_f32_e64 v109, v109
    v_smfmac_f32_32x32x32_bf16 v[60:75], v[164:167], v[132:139], v172
    v_exp_f32 v110, v110
    v_exp_f32 v111, v111
    v_exp_f32 v112, v112
    v_exp_f32 v113, v113
    v_mfma_f32_32x32x16_bf16 v[124:139], v[152:155], v[144:147], v[92:107]
    ds_read_b128 v[152:155], v173 offset:1024
    v_add_u32 v174, v175, v174
    v_exp_f32 v114, v114
    v_exp_f32_e64 v115, v115
    ds_read_b128 v[156:159], v174 offset:0
    v_exp_f32 v116, v116
    v_exp_f32 v117, v117
    v_smfmac_f32_32x32x32_bf16 v[44:59], v[160:163], v[108:115], v172
    ds_read_b128 v[164:167], v174 offset:512
    v_exp_f32 v118, v118
    v_exp_f32 v119, v119
    v_exp_f32_e64 v120, v120
    buffer_load_dwordx4 a[40:43], v0, s[4:7], s60 offen offset:2048 sc1
    v_exp_f32 v121, v121
    v_exp_f32 v122, v122
    v_exp_f32 v123, v123
    v_exp_f32 v124, v124
    v_exp_f32_e64 v125, v125
    v_smfmac_f32_32x32x32_bf16 v[44:59], v[168:171], v[116:123], v172
    v_exp_f32 v126, v126
    v_exp_f32 v127, v127
    v_exp_f32 v128, v128
    v_exp_f32 v129, v129
    v_mfma_f32_32x32x16_bf16 v[108:123], v[148:151], v[140:143], v[76:91]
    v_exp_f32 v130, v130
    v_exp_f32 v131, v131
    v_exp_f32 v132, v132
    v_exp_f32 v133, v133
    v_smfmac_f32_32x32x32_bf16 v[60:75], v[160:163], v[124:131], v172
    s_waitcnt lgkmcnt(0)
    v_exp_f32 v134, v134
    v_exp_f32 v135, v135
    v_exp_f32 v136, v136
    buffer_load_dwordx4 a[44:47], v0, s[4:7], s60 offen offset:3072 sc1
    v_exp_f32 v137, v137
    v_exp_f32 v138, v138
    v_exp_f32 v139, v139
    v_exp_f32 v108, v108
    v_exp_f32_e64 v109, v109
    v_smfmac_f32_32x32x32_bf16 v[60:75], v[168:171], v[132:139], v172
    v_exp_f32 v110, v110
    v_exp_f32 v111, v111
    v_exp_f32 v112, v112
    v_exp_f32 v113, v113
    v_mfma_f32_32x32x16_bf16 v[124:139], v[148:151], v[144:147], v[92:107]
    ds_read_b128 v[148:151], v173 offset:2048
    v_exp_f32 v114, v114
    v_exp_f32 v115, v115
    ds_read_b128 v[160:163], v174 offset:1024
    v_exp_f32 v116, v116
    v_exp_f32 v117, v117
    v_smfmac_f32_32x32x32_bf16 v[44:59], v[156:159], v[108:115], v172
    ds_read_b128 v[168:171], v174 offset:1536
    v_exp_f32 v118, v118
    v_exp_f32 v119, v119
    v_exp_f32_e64 v120, v120
    buffer_load_dwordx4 a[48:51], v5, s[4:7], s60 offen offset:0 sc1
    v_exp_f32 v121, v121
    v_exp_f32 v122, v122
    v_exp_f32 v123, v123
    v_exp_f32 v124, v124
    v_exp_f32_e64 v125, v125
    v_smfmac_f32_32x32x32_bf16 v[44:59], v[164:167], v[116:123], v172
    v_exp_f32 v126, v126
    v_exp_f32 v127, v127
    v_exp_f32 v128, v128
    v_exp_f32 v129, v129
    v_mfma_f32_32x32x16_bf16 v[108:123], v[152:155], v[140:143], v[76:91]
    v_exp_f32 v130, v130
    v_exp_f32 v131, v131
    buffer_store_dwordx4 v[8:11], v29, s[4:7], s72 offen offset:0 sc1
    v_exp_f32 v132, v132
    v_exp_f32 v133, v133
    v_smfmac_f32_32x32x32_bf16 v[60:75], v[156:159], v[124:131], v172
    s_waitcnt lgkmcnt(0)
    v_exp_f32 v134, v134
    v_exp_f32 v135, v135
    v_exp_f32 v136, v136
    buffer_load_dwordx4 a[52:55], v5, s[4:7], s60 offen offset:1024 sc1
    v_exp_f32 v137, v137
    v_exp_f32 v138, v138
    v_exp_f32 v139, v139
    v_exp_f32 v108, v108
    v_exp_f32_e64 v109, v109
    v_smfmac_f32_32x32x32_bf16 v[60:75], v[164:167], v[132:139], v172
    v_exp_f32 v110, v110
    v_exp_f32 v111, v111
    v_exp_f32 v112, v112
    v_exp_f32 v113, v113
    v_mfma_f32_32x32x16_bf16 v[124:139], v[152:155], v[144:147], v[92:107]
    ds_read_b128 v[152:155], v173 offset:3072
    v_exp_f32 v114, v114
    v_exp_f32 v115, v115
    ds_read_b128 v[156:159], v174 offset:2048
    v_exp_f32 v116, v116
    v_exp_f32 v117, v117
    v_smfmac_f32_32x32x32_bf16 v[44:59], v[160:163], v[108:115], v172
    ds_read_b128 v[164:167], v174 offset:2560
    v_exp_f32 v118, v118
    v_exp_f32 v119, v119
    v_exp_f32_e64 v120, v120
    buffer_load_dwordx4 a[56:59], v5, s[4:7], s60 offen offset:2048 sc1
    v_exp_f32 v121, v121
    v_exp_f32 v122, v122
    v_exp_f32 v123, v123
    v_exp_f32 v124, v124
    v_exp_f32_e64 v125, v125
    v_smfmac_f32_32x32x32_bf16 v[44:59], v[168:171], v[116:123], v172
    v_exp_f32 v126, v126
    v_exp_f32 v127, v127
    v_exp_f32 v128, v128
    v_exp_f32 v129, v129
    v_mfma_f32_32x32x16_bf16 v[108:123], v[148:151], v[140:143], v[76:91]
    v_exp_f32 v130, v130
    v_exp_f32 v131, v131
    v_exp_f32 v132, v132
    v_exp_f32 v133, v133
    v_smfmac_f32_32x32x32_bf16 v[60:75], v[160:163], v[124:131], v172
    s_waitcnt lgkmcnt(0)
    v_exp_f32 v134, v134
    v_exp_f32 v135, v135
    v_exp_f32 v136, v136
    buffer_load_dwordx4 a[60:63], v5, s[4:7], s60 offen offset:3072 sc1
    v_exp_f32 v137, v137
    v_exp_f32 v138, v138
    v_exp_f32 v139, v139
    v_exp_f32 v108, v108
    v_exp_f32_e64 v109, v109
    v_smfmac_f32_32x32x32_bf16 v[60:75], v[168:171], v[132:139], v172
    v_exp_f32 v110, v110
    v_exp_f32 v111, v111
    v_exp_f32 v112, v112
    v_exp_f32 v113, v113
    v_mfma_f32_32x32x16_bf16 v[124:139], v[148:151], v[144:147], v[92:107]
    ds_read_b128 v[148:151], v173 offset:8192
    v_exp_f32 v114, v114
    v_exp_f32 v115, v115
    ds_read_b128 v[160:163], v174 offset:3072
    v_exp_f32 v116, v116
    v_exp_f32 v117, v117
    v_smfmac_f32_32x32x32_bf16 v[44:59], v[156:159], v[108:115], v172
    ds_read_b128 v[168:171], v174 offset:3584
    v_exp_f32 v118, v118
    v_exp_f32 v119, v119
    v_exp_f32_e64 v120, v120
    buffer_load_dwordx4 a[64:67], v0, s[4:7], s61 offen offset:0 sc1
    v_exp_f32 v121, v121
    v_exp_f32 v122, v122
    v_exp_f32 v123, v123
    v_exp_f32 v124, v124
    v_exp_f32_e64 v125, v125
    v_smfmac_f32_32x32x32_bf16 v[44:59], v[164:167], v[116:123], v172
    v_exp_f32 v126, v126
    v_exp_f32 v127, v127
    v_exp_f32 v128, v128
    v_exp_f32 v129, v129
    v_mfma_f32_32x32x16_bf16 v[108:123], v[152:155], v[140:143], v[76:91]
    v_exp_f32 v130, v130
    v_exp_f32 v131, v131
    buffer_store_dwordx4 v[8:11], v29, s[4:7], s72 offen offset:1024 sc1
    v_exp_f32 v132, v132
    v_exp_f32 v133, v133
    v_smfmac_f32_32x32x32_bf16 v[60:75], v[156:159], v[124:131], v172
    s_waitcnt lgkmcnt(0)
    v_exp_f32 v134, v134
    v_exp_f32 v135, v135
    v_exp_f32 v136, v136
    buffer_load_dwordx4 a[68:71], v0, s[4:7], s61 offen offset:1024 sc1
    v_exp_f32 v137, v137
    v_exp_f32 v138, v138
    v_exp_f32 v139, v139
    v_exp_f32 v108, v108
    v_exp_f32_e64 v109, v109
    v_smfmac_f32_32x32x32_bf16 v[60:75], v[164:167], v[132:139], v172
    v_exp_f32 v110, v110
    v_exp_f32 v111, v111
    v_exp_f32 v112, v112
    v_exp_f32 v113, v113
    v_mfma_f32_32x32x16_bf16 v[124:139], v[152:155], v[144:147], v[92:107]
    ds_read_b128 v[152:155], v173 offset:9216
    v_add_u32 v174, v175, v174
    v_exp_f32 v114, v114
    v_exp_f32_e64 v115, v115
    ds_read_b128 v[156:159], v174 offset:0
    v_exp_f32 v116, v116
    v_exp_f32 v117, v117
    v_smfmac_f32_32x32x32_bf16 v[44:59], v[160:163], v[108:115], v172
    ds_read_b128 v[164:167], v174 offset:512
    v_exp_f32 v118, v118
    v_exp_f32 v119, v119
    v_exp_f32_e64 v120, v120
    buffer_load_dwordx4 a[72:75], v0, s[4:7], s61 offen offset:2048 sc1
    v_exp_f32 v121, v121
    v_exp_f32 v122, v122
    v_exp_f32 v123, v123
    v_exp_f32 v124, v124
    v_exp_f32_e64 v125, v125
    v_smfmac_f32_32x32x32_bf16 v[44:59], v[168:171], v[116:123], v172
    v_exp_f32 v126, v126
    v_exp_f32 v127, v127
    v_exp_f32 v128, v128
    v_exp_f32 v129, v129
    v_mfma_f32_32x32x16_bf16 v[108:123], v[148:151], v[140:143], v[76:91]
    v_exp_f32 v130, v130
    v_exp_f32 v131, v131
    v_exp_f32 v132, v132
    v_exp_f32 v133, v133
    v_smfmac_f32_32x32x32_bf16 v[60:75], v[160:163], v[124:131], v172
    s_waitcnt lgkmcnt(0)
    v_exp_f32 v134, v134
    v_exp_f32 v135, v135
    v_exp_f32 v136, v136
    buffer_load_dwordx4 a[76:79], v0, s[4:7], s61 offen offset:3072 sc1
    v_exp_f32 v137, v137
    v_exp_f32 v138, v138
    v_exp_f32 v139, v139
    v_exp_f32 v108, v108
    v_exp_f32_e64 v109, v109
    v_smfmac_f32_32x32x32_bf16 v[60:75], v[168:171], v[132:139], v172
    v_exp_f32 v110, v110
    v_exp_f32 v111, v111
    v_exp_f32 v112, v112
    v_exp_f32 v113, v113
    v_mfma_f32_32x32x16_bf16 v[124:139], v[148:151], v[144:147], v[92:107]
    ds_read_b128 v[148:151], v173 offset:10240
    v_exp_f32 v114, v114
    v_exp_f32 v115, v115
    ds_read_b128 v[160:163], v174 offset:1024
    v_exp_f32 v116, v116
    v_exp_f32 v117, v117
    v_smfmac_f32_32x32x32_bf16 v[44:59], v[156:159], v[108:115], v172
    ds_read_b128 v[168:171], v174 offset:1536
    v_exp_f32 v118, v118
    v_exp_f32 v119, v119
    v_exp_f32_e64 v120, v120
    buffer_load_dwordx4 a[80:83], v5, s[4:7], s61 offen offset:0 sc1
    v_exp_f32 v121, v121
    v_exp_f32 v122, v122
    v_exp_f32 v123, v123
    v_exp_f32 v124, v124
    v_exp_f32_e64 v125, v125
    v_smfmac_f32_32x32x32_bf16 v[44:59], v[164:167], v[116:123], v172
    v_exp_f32 v126, v126
    v_exp_f32 v127, v127
    v_exp_f32 v128, v128
    v_exp_f32 v129, v129
    v_mfma_f32_32x32x16_bf16 v[108:123], v[152:155], v[140:143], v[76:91]
    v_exp_f32 v130, v130
    v_exp_f32 v131, v131
    s_add_u32 s94, s71, 114688
    buffer_store_dwordx4 v[8:11], v29, s[4:7], s94 offen offset:0 sc1
    v_exp_f32 v132, v132
    v_exp_f32 v133, v133
    v_smfmac_f32_32x32x32_bf16 v[60:75], v[156:159], v[124:131], v172
    s_waitcnt lgkmcnt(0)
    v_exp_f32 v134, v134
    v_exp_f32 v135, v135
    v_exp_f32 v136, v136
    buffer_load_dwordx4 a[84:87], v5, s[4:7], s61 offen offset:1024 sc1
    v_exp_f32 v137, v137
    v_exp_f32 v138, v138
    v_exp_f32 v139, v139
    v_exp_f32 v108, v108
    v_exp_f32_e64 v109, v109
    v_smfmac_f32_32x32x32_bf16 v[60:75], v[164:167], v[132:139], v172
    v_exp_f32 v110, v110
    v_exp_f32 v111, v111
    v_exp_f32 v112, v112
    v_exp_f32 v113, v113
    v_mfma_f32_32x32x16_bf16 v[124:139], v[152:155], v[144:147], v[92:107]
    ds_read_b128 v[152:155], v173 offset:11264
    v_exp_f32 v114, v114
    v_exp_f32 v115, v115
    ds_read_b128 v[156:159], v174 offset:2048
    v_exp_f32 v116, v116
    v_exp_f32 v117, v117
    v_smfmac_f32_32x32x32_bf16 v[44:59], v[160:163], v[108:115], v172
    ds_read_b128 v[164:167], v174 offset:2560
    v_exp_f32 v118, v118
    v_exp_f32 v119, v119
    v_exp_f32_e64 v120, v120
    buffer_load_dwordx4 a[88:91], v5, s[4:7], s61 offen offset:2048 sc1
    v_exp_f32 v121, v121
    v_exp_f32 v122, v122
    v_exp_f32 v123, v123
    v_exp_f32 v124, v124
    v_exp_f32_e64 v125, v125
    v_smfmac_f32_32x32x32_bf16 v[44:59], v[168:171], v[116:123], v172
    v_exp_f32 v126, v126
    v_exp_f32 v127, v127
    v_exp_f32 v128, v128
    v_exp_f32 v129, v129
    v_mfma_f32_32x32x16_bf16 v[108:123], v[148:151], v[140:143], v[76:91]
    v_exp_f32 v130, v130
    v_exp_f32 v131, v131
    v_exp_f32 v132, v132
    v_exp_f32 v133, v133
    v_smfmac_f32_32x32x32_bf16 v[60:75], v[160:163], v[124:131], v172
    s_waitcnt lgkmcnt(0)
    v_exp_f32 v134, v134
    v_exp_f32 v135, v135
    v_exp_f32 v136, v136
    buffer_load_dwordx4 a[92:95], v5, s[4:7], s61 offen offset:3072 sc1
    v_exp_f32 v137, v137
    v_exp_f32 v138, v138
    v_exp_f32 v139, v139
    v_exp_f32 v108, v108
    v_exp_f32_e64 v109, v109
    v_smfmac_f32_32x32x32_bf16 v[60:75], v[168:171], v[132:139], v172
    v_exp_f32 v110, v110
    v_exp_f32 v111, v111
    v_exp_f32 v112, v112
    v_exp_f32 v113, v113
    v_mfma_f32_32x32x16_bf16 v[124:139], v[148:151], v[144:147], v[92:107]
    ds_read_b128 v[148:151], v173 offset:16384
    v_exp_f32 v114, v114
    v_exp_f32 v115, v115
    ds_read_b128 v[160:163], v174 offset:3072
    v_exp_f32 v116, v116
    v_exp_f32 v117, v117
    v_smfmac_f32_32x32x32_bf16 v[44:59], v[156:159], v[108:115], v172
    ds_read_b128 v[168:171], v174 offset:3584
    v_exp_f32 v118, v118
    v_exp_f32 v119, v119
    v_exp_f32_e64 v120, v120
    buffer_load_dwordx4 a[96:99], v0, s[4:7], s62 offen offset:0 sc1
    v_exp_f32 v121, v121
    v_exp_f32 v122, v122
    v_exp_f32 v123, v123
    v_exp_f32 v124, v124
    v_exp_f32_e64 v125, v125
    v_smfmac_f32_32x32x32_bf16 v[44:59], v[164:167], v[116:123], v172
    v_exp_f32 v126, v126
    v_exp_f32 v127, v127
    v_exp_f32 v128, v128
    v_exp_f32 v129, v129
    v_mfma_f32_32x32x16_bf16 v[108:123], v[152:155], v[140:143], v[76:91]
    v_exp_f32 v130, v130
    v_exp_f32 v131, v131
    s_add_u32 s94, s71, 114688
    buffer_store_dwordx4 v[8:11], v29, s[4:7], s94 offen offset:1024 sc1
    v_exp_f32 v132, v132
    v_exp_f32 v133, v133
    v_smfmac_f32_32x32x32_bf16 v[60:75], v[156:159], v[124:131], v172
    s_waitcnt lgkmcnt(0)
    v_exp_f32 v134, v134
    v_exp_f32 v135, v135
    v_exp_f32 v136, v136
    buffer_load_dwordx4 a[100:103], v0, s[4:7], s62 offen offset:1024 sc1
    v_exp_f32 v137, v137
    v_exp_f32 v138, v138
    v_exp_f32 v139, v139
    v_exp_f32 v108, v108
    v_exp_f32_e64 v109, v109
    v_smfmac_f32_32x32x32_bf16 v[60:75], v[164:167], v[132:139], v172
    v_exp_f32 v110, v110
    v_exp_f32 v111, v111
    v_exp_f32 v112, v112
    v_exp_f32 v113, v113
    v_mfma_f32_32x32x16_bf16 v[124:139], v[152:155], v[144:147], v[92:107]
    ds_read_b128 v[152:155], v173 offset:17408
    v_add_u32 v174, v175, v174
    v_exp_f32 v114, v114
    v_exp_f32_e64 v115, v115
    ds_read_b128 v[156:159], v174 offset:0
    v_exp_f32 v116, v116
    v_exp_f32 v117, v117
    v_smfmac_f32_32x32x32_bf16 v[44:59], v[160:163], v[108:115], v172
    ds_read_b128 v[164:167], v174 offset:512
    v_exp_f32 v118, v118
    v_exp_f32 v119, v119
    v_exp_f32_e64 v120, v120
    buffer_load_dwordx4 a[104:107], v0, s[4:7], s62 offen offset:2048 sc1
    v_exp_f32 v121, v121
    v_exp_f32 v122, v122
    v_exp_f32 v123, v123
    v_exp_f32 v124, v124
    v_exp_f32_e64 v125, v125
    v_smfmac_f32_32x32x32_bf16 v[44:59], v[168:171], v[116:123], v172
    v_exp_f32 v126, v126
    v_exp_f32 v127, v127
    v_exp_f32 v128, v128
    v_exp_f32 v129, v129
    v_mfma_f32_32x32x16_bf16 v[108:123], v[148:151], v[140:143], v[76:91]
    v_exp_f32 v130, v130
    v_exp_f32 v131, v131
    v_exp_f32 v132, v132
    v_exp_f32 v133, v133
    v_smfmac_f32_32x32x32_bf16 v[60:75], v[160:163], v[124:131], v172
    s_waitcnt lgkmcnt(0)
    v_exp_f32 v134, v134
    v_exp_f32 v135, v135
    v_exp_f32 v136, v136
    buffer_load_dwordx4 a[108:111], v0, s[4:7], s62 offen offset:3072 sc1
    v_exp_f32 v137, v137
    v_exp_f32 v138, v138
    v_exp_f32 v139, v139
    v_exp_f32 v108, v108
    v_exp_f32_e64 v109, v109
    v_smfmac_f32_32x32x32_bf16 v[60:75], v[168:171], v[132:139], v172
    v_exp_f32 v110, v110
    v_exp_f32 v111, v111
    v_exp_f32 v112, v112
    v_exp_f32 v113, v113
    v_mfma_f32_32x32x16_bf16 v[124:139], v[148:151], v[144:147], v[92:107]
    ds_read_b128 v[148:151], v173 offset:18432
    v_exp_f32 v114, v114
    v_exp_f32 v115, v115
    ds_read_b128 v[160:163], v174 offset:1024
    v_exp_f32 v116, v116
    v_exp_f32 v117, v117
    v_smfmac_f32_32x32x32_bf16 v[44:59], v[156:159], v[108:115], v172
    ds_read_b128 v[168:171], v174 offset:1536
    v_exp_f32 v118, v118
    v_exp_f32 v119, v119
    v_exp_f32_e64 v120, v120
    buffer_load_dwordx4 a[112:115], v5, s[4:7], s62 offen offset:0 sc1
    v_exp_f32 v121, v121
    v_exp_f32 v122, v122
    v_exp_f32 v123, v123
    v_exp_f32 v124, v124
    v_exp_f32_e64 v125, v125
    v_smfmac_f32_32x32x32_bf16 v[44:59], v[164:167], v[116:123], v172
    v_exp_f32 v126, v126
    v_exp_f32 v127, v127
    v_exp_f32 v128, v128
    v_exp_f32 v129, v129
    v_mfma_f32_32x32x16_bf16 v[108:123], v[152:155], v[140:143], v[76:91]
    v_exp_f32 v130, v130
    v_exp_f32 v131, v131
    s_add_u32 s94, s72, 114688
    buffer_store_dwordx4 v[8:11], v29, s[4:7], s94 offen offset:0 sc1
    v_exp_f32 v132, v132
    v_exp_f32 v133, v133
    v_smfmac_f32_32x32x32_bf16 v[60:75], v[156:159], v[124:131], v172
    s_waitcnt lgkmcnt(0)
    v_exp_f32 v134, v134
    v_exp_f32 v135, v135
    v_exp_f32 v136, v136
    buffer_load_dwordx4 a[116:119], v5, s[4:7], s62 offen offset:1024 sc1
    v_exp_f32 v137, v137
    v_exp_f32 v138, v138
    v_exp_f32 v139, v139
    v_exp_f32 v108, v108
    v_exp_f32_e64 v109, v109
    v_smfmac_f32_32x32x32_bf16 v[60:75], v[164:167], v[132:139], v172
    v_exp_f32 v110, v110
    v_exp_f32 v111, v111
    v_exp_f32 v112, v112
    v_exp_f32 v113, v113
    v_mfma_f32_32x32x16_bf16 v[124:139], v[152:155], v[144:147], v[92:107]
    ds_read_b128 v[152:155], v173 offset:19456
    v_exp_f32 v114, v114
    v_exp_f32 v115, v115
    ds_read_b128 v[156:159], v174 offset:2048
    v_exp_f32 v116, v116
    v_exp_f32 v117, v117
    v_smfmac_f32_32x32x32_bf16 v[44:59], v[160:163], v[108:115], v172
    ds_read_b128 v[164:167], v174 offset:2560
    v_exp_f32 v118, v118
    v_exp_f32 v119, v119
    v_exp_f32_e64 v120, v120
    buffer_load_dwordx4 a[120:123], v5, s[4:7], s62 offen offset:2048 sc1
    v_exp_f32 v121, v121
    v_exp_f32 v122, v122
    v_exp_f32 v123, v123
    v_exp_f32 v124, v124
    v_exp_f32_e64 v125, v125
    v_smfmac_f32_32x32x32_bf16 v[44:59], v[168:171], v[116:123], v172
    v_exp_f32 v126, v126
    v_exp_f32 v127, v127
    v_exp_f32 v128, v128
    v_exp_f32 v129, v129
    v_mfma_f32_32x32x16_bf16 v[108:123], v[148:151], v[140:143], v[76:91]
    v_exp_f32 v130, v130
    v_exp_f32 v131, v131
    v_exp_f32 v132, v132
    v_exp_f32 v133, v133
    v_smfmac_f32_32x32x32_bf16 v[60:75], v[160:163], v[124:131], v172
    s_waitcnt lgkmcnt(0)
    v_exp_f32 v134, v134
    v_exp_f32 v135, v135
    v_exp_f32 v136, v136
    buffer_load_dwordx4 a[124:127], v5, s[4:7], s62 offen offset:3072 sc1
    v_exp_f32 v137, v137
    v_exp_f32 v138, v138
    v_exp_f32 v139, v139
    v_exp_f32 v108, v108
    v_exp_f32_e64 v109, v109
    v_smfmac_f32_32x32x32_bf16 v[60:75], v[168:171], v[132:139], v172
    v_exp_f32 v110, v110
    v_exp_f32 v111, v111
    v_exp_f32 v112, v112
    v_exp_f32 v113, v113
    v_mfma_f32_32x32x16_bf16 v[124:139], v[148:151], v[144:147], v[92:107]
    ds_read_b128 v[148:151], v173 offset:24576
    v_exp_f32 v114, v114
    v_exp_f32 v115, v115
    ds_read_b128 v[160:163], v174 offset:3072
    v_exp_f32 v116, v116
    v_exp_f32 v117, v117
    v_smfmac_f32_32x32x32_bf16 v[44:59], v[156:159], v[108:115], v172
    ds_read_b128 v[168:171], v174 offset:3584
    v_exp_f32 v118, v118
    v_exp_f32 v119, v119
    v_exp_f32_e64 v120, v120
    buffer_load_dwordx4 v[244:247], v0, s[4:7], s63 offen offset:0 sc1
    v_exp_f32 v121, v121
    v_exp_f32 v122, v122
    v_exp_f32 v123, v123
    v_exp_f32 v124, v124
    v_exp_f32_e64 v125, v125
    v_smfmac_f32_32x32x32_bf16 v[44:59], v[164:167], v[116:123], v172
    v_exp_f32 v126, v126
    v_exp_f32 v127, v127
    v_exp_f32 v128, v128
    v_exp_f32 v129, v129
    v_mfma_f32_32x32x16_bf16 v[108:123], v[152:155], v[140:143], v[76:91]
    v_exp_f32 v130, v130
    v_exp_f32 v131, v131
    s_add_u32 s94, s72, 114688
    buffer_store_dwordx4 v[8:11], v29, s[4:7], s94 offen offset:1024 sc1
    v_exp_f32 v132, v132
    v_exp_f32 v133, v133
    v_smfmac_f32_32x32x32_bf16 v[60:75], v[156:159], v[124:131], v172
    s_waitcnt lgkmcnt(0)
    v_exp_f32 v134, v134
    v_exp_f32 v135, v135
    v_exp_f32 v136, v136
    buffer_load_dwordx4 a[128:131], v0, s[4:7], s64 offen offset:0 sc1
    v_exp_f32 v137, v137
    v_exp_f32 v138, v138
    v_exp_f32 v139, v139
    v_exp_f32 v108, v108
    v_exp_f32_e64 v109, v109
    v_smfmac_f32_32x32x32_bf16 v[60:75], v[164:167], v[132:139], v172
    v_exp_f32 v110, v110
    v_exp_f32 v111, v111
    v_exp_f32 v112, v112
    v_exp_f32 v113, v113
    v_mfma_f32_32x32x16_bf16 v[124:139], v[152:155], v[144:147], v[92:107]
    ds_read_b128 v[152:155], v173 offset:25600
    v_add_u32 v174, v175, v174
    v_exp_f32 v114, v114
    v_exp_f32_e64 v115, v115
    ds_read_b128 v[156:159], v174 offset:0
    v_exp_f32 v116, v116
    v_exp_f32 v117, v117
    v_smfmac_f32_32x32x32_bf16 v[44:59], v[160:163], v[108:115], v172
    ds_read_b128 v[164:167], v174 offset:512
    v_exp_f32 v118, v118
    v_exp_f32 v119, v119
    v_exp_f32_e64 v120, v120
    buffer_load_dwordx4 a[132:135], v0, s[4:7], s64 offen offset:1024 sc1
    v_exp_f32 v121, v121
    v_exp_f32 v122, v122
    v_exp_f32 v123, v123
    v_exp_f32 v124, v124
    v_exp_f32_e64 v125, v125
    v_smfmac_f32_32x32x32_bf16 v[44:59], v[168:171], v[116:123], v172
    v_exp_f32 v126, v126
    v_exp_f32 v127, v127
    v_exp_f32 v128, v128
    v_exp_f32 v129, v129
    v_mfma_f32_32x32x16_bf16 v[108:123], v[148:151], v[140:143], v[76:91]
    v_exp_f32 v130, v130
    v_exp_f32 v131, v131
    v_exp_f32 v132, v132
    v_exp_f32 v133, v133
    v_smfmac_f32_32x32x32_bf16 v[60:75], v[160:163], v[124:131], v172
    s_waitcnt lgkmcnt(0)
    v_exp_f32 v134, v134
    v_exp_f32 v135, v135
    v_exp_f32 v136, v136
    buffer_load_dwordx4 a[136:139], v0, s[4:7], s64 offen offset:2048 sc1
    v_exp_f32 v137, v137
    v_exp_f32 v138, v138
    v_exp_f32 v139, v139
    v_exp_f32 v108, v108
    v_exp_f32_e64 v109, v109
    v_smfmac_f32_32x32x32_bf16 v[60:75], v[168:171], v[132:139], v172
    v_exp_f32 v110, v110
    v_exp_f32 v111, v111
    v_exp_f32 v112, v112
    v_exp_f32 v113, v113
    v_mfma_f32_32x32x16_bf16 v[124:139], v[148:151], v[144:147], v[92:107]
    ds_read_b128 v[148:151], v173 offset:26624
    v_exp_f32 v114, v114
    v_exp_f32 v115, v115
    ds_read_b128 v[160:163], v174 offset:1024
    v_exp_f32 v116, v116
    v_exp_f32 v117, v117
    v_smfmac_f32_32x32x32_bf16 v[44:59], v[156:159], v[108:115], v172
    ds_read_b128 v[168:171], v174 offset:1536
    v_exp_f32 v118, v118
    v_exp_f32 v119, v119
    v_exp_f32_e64 v120, v120
    buffer_load_dwordx4 a[140:143], v0, s[4:7], s64 offen offset:3072 sc1
    v_exp_f32 v121, v121
    v_exp_f32 v122, v122
    v_exp_f32 v123, v123
    v_exp_f32 v124, v124
    v_exp_f32_e64 v125, v125
    v_smfmac_f32_32x32x32_bf16 v[44:59], v[164:167], v[116:123], v172
    v_exp_f32 v126, v126
    v_exp_f32 v127, v127
    v_exp_f32 v128, v128
    v_exp_f32 v129, v129
    v_mfma_f32_32x32x16_bf16 v[108:123], v[152:155], v[140:143], v[76:91]
    v_exp_f32 v130, v130
    v_exp_f32 v131, v131
    buffer_load_dword v27, v25, s[4:7], s69 offen sc1
    v_exp_f32 v132, v132
    v_exp_f32 v133, v133
    v_smfmac_f32_32x32x32_bf16 v[60:75], v[156:159], v[124:131], v172
    s_waitcnt lgkmcnt(0)
    v_exp_f32 v134, v134
    v_exp_f32 v135, v135
    v_exp_f32 v136, v136
    buffer_load_dwordx4 a[144:147], v5, s[4:7], s64 offen offset:0 sc1
    v_exp_f32 v137, v137
    v_exp_f32 v138, v138
    v_exp_f32 v139, v139
    v_exp_f32 v108, v108
    v_exp_f32_e64 v109, v109
    v_smfmac_f32_32x32x32_bf16 v[60:75], v[164:167], v[132:139], v172
    v_exp_f32 v110, v110
    v_exp_f32 v111, v111
    v_exp_f32 v112, v112
    v_exp_f32 v113, v113
    v_mfma_f32_32x32x16_bf16 v[124:139], v[152:155], v[144:147], v[92:107]
    ds_read_b128 v[152:155], v173 offset:27648
    v_exp_f32 v114, v114
    v_exp_f32 v115, v115
    ds_read_b128 v[156:159], v174 offset:2048
    v_exp_f32 v116, v116
    v_exp_f32 v117, v117
    v_smfmac_f32_32x32x32_bf16 v[44:59], v[160:163], v[108:115], v172
    ds_read_b128 v[164:167], v174 offset:2560
    v_exp_f32 v118, v118
    v_exp_f32 v119, v119
    v_exp_f32_e64 v120, v120
    buffer_load_dwordx4 a[148:151], v5, s[4:7], s64 offen offset:1024 sc1
    v_exp_f32 v121, v121
    v_exp_f32 v122, v122
    v_exp_f32 v123, v123
    v_exp_f32 v124, v124
    v_exp_f32_e64 v125, v125
    v_smfmac_f32_32x32x32_bf16 v[44:59], v[168:171], v[116:123], v172
    v_exp_f32 v126, v126
    v_exp_f32 v127, v127
    v_exp_f32 v128, v128
    v_exp_f32 v129, v129
    v_mfma_f32_32x32x16_bf16 v[108:123], v[148:151], v[140:143], v[76:91]
    v_exp_f32 v130, v130
    v_exp_f32 v131, v131
    v_exp_f32 v132, v132
    v_exp_f32 v133, v133
    v_smfmac_f32_32x32x32_bf16 v[60:75], v[160:163], v[124:131], v172
    s_waitcnt lgkmcnt(0)
    v_exp_f32 v134, v134
    v_exp_f32 v135, v135
    v_exp_f32 v136, v136
    buffer_load_dwordx4 a[152:155], v5, s[4:7], s64 offen offset:2048 sc1
    v_exp_f32 v137, v137
    v_exp_f32 v138, v138
    v_exp_f32 v139, v139
    v_exp_f32 v108, v108
    v_exp_f32_e64 v109, v109
    v_smfmac_f32_32x32x32_bf16 v[60:75], v[168:171], v[132:139], v172
    v_exp_f32 v110, v110
    v_exp_f32 v111, v111
    v_exp_f32 v112, v112
    v_exp_f32 v113, v113
    v_mfma_f32_32x32x16_bf16 v[124:139], v[148:151], v[144:147], v[92:107]
    ds_read_b128 v[148:151], v173 offset:32768
    v_exp_f32 v114, v114
    v_exp_f32 v115, v115
    ds_read_b128 v[160:163], v174 offset:3072
    v_exp_f32 v116, v116
    v_exp_f32 v117, v117
    v_smfmac_f32_32x32x32_bf16 v[44:59], v[156:159], v[108:115], v172
    ds_read_b128 v[168:171], v174 offset:3584
    v_exp_f32 v118, v118
    v_exp_f32 v119, v119
    v_exp_f32_e64 v120, v120
    buffer_load_dwordx4 a[156:159], v5, s[4:7], s64 offen offset:3072 sc1
    v_exp_f32 v121, v121
    v_exp_f32 v122, v122
    v_exp_f32 v123, v123
    v_exp_f32 v124, v124
    v_exp_f32_e64 v125, v125
    v_smfmac_f32_32x32x32_bf16 v[44:59], v[164:167], v[116:123], v172
    v_exp_f32 v126, v126
    v_exp_f32 v127, v127
    v_exp_f32 v128, v128
    v_exp_f32 v129, v129
    v_mfma_f32_32x32x16_bf16 v[108:123], v[152:155], v[140:143], v[76:91]
    v_exp_f32 v130, v130
    v_exp_f32 v131, v131
    v_exp_f32 v132, v132
    v_exp_f32 v133, v133
    v_smfmac_f32_32x32x32_bf16 v[60:75], v[156:159], v[124:131], v172
    s_waitcnt lgkmcnt(0)
    v_exp_f32 v134, v134
    v_exp_f32 v135, v135
    v_exp_f32 v136, v136
    buffer_load_dwordx4 a[160:163], v0, s[4:7], s65 offen offset:0 sc1
    v_exp_f32 v137, v137
    v_exp_f32 v138, v138
    v_exp_f32 v139, v139
    v_exp_f32 v108, v108
    v_exp_f32_e64 v109, v109
    v_smfmac_f32_32x32x32_bf16 v[60:75], v[164:167], v[132:139], v172
    v_exp_f32 v110, v110
    v_exp_f32 v111, v111
    v_exp_f32 v112, v112
    v_exp_f32 v113, v113
    v_mfma_f32_32x32x16_bf16 v[124:139], v[152:155], v[144:147], v[92:107]
    ds_read_b128 v[152:155], v173 offset:33792
    v_add_u32 v174, v175, v174
    v_exp_f32 v114, v114
    v_exp_f32_e64 v115, v115
    ds_read_b128 v[156:159], v174 offset:0
    v_exp_f32 v116, v116
    v_exp_f32 v117, v117
    v_smfmac_f32_32x32x32_bf16 v[44:59], v[160:163], v[108:115], v172
    ds_read_b128 v[164:167], v174 offset:512
    v_exp_f32 v118, v118
    v_exp_f32 v119, v119
    v_exp_f32_e64 v120, v120
    buffer_load_dwordx4 a[164:167], v0, s[4:7], s65 offen offset:1024 sc1
    v_exp_f32 v121, v121
    v_exp_f32 v122, v122
    v_exp_f32 v123, v123
    v_exp_f32 v124, v124
    v_exp_f32_e64 v125, v125
    v_smfmac_f32_32x32x32_bf16 v[44:59], v[168:171], v[116:123], v172
    v_exp_f32 v126, v126
    v_exp_f32 v127, v127
    v_exp_f32 v128, v128
    v_exp_f32 v129, v129
    v_mfma_f32_32x32x16_bf16 v[108:123], v[148:151], v[140:143], v[76:91]
    v_exp_f32 v130, v130
    v_exp_f32 v131, v131
    v_exp_f32 v132, v132
    v_exp_f32 v133, v133
    v_smfmac_f32_32x32x32_bf16 v[60:75], v[160:163], v[124:131], v172
    s_waitcnt lgkmcnt(0)
    v_exp_f32 v134, v134
    v_exp_f32 v135, v135
    v_exp_f32 v136, v136
    buffer_load_dwordx4 a[168:171], v0, s[4:7], s65 offen offset:2048 sc1
    v_exp_f32 v137, v137
    v_exp_f32 v138, v138
    v_exp_f32 v139, v139
    v_exp_f32 v108, v108
    v_exp_f32_e64 v109, v109
    v_smfmac_f32_32x32x32_bf16 v[60:75], v[168:171], v[132:139], v172
    v_exp_f32 v110, v110
    v_exp_f32 v111, v111
    v_exp_f32 v112, v112
    v_exp_f32 v113, v113
    v_mfma_f32_32x32x16_bf16 v[124:139], v[148:151], v[144:147], v[92:107]
    ds_read_b128 v[148:151], v173 offset:34816
    v_exp_f32 v114, v114
    v_exp_f32 v115, v115
    ds_read_b128 v[160:163], v174 offset:1024
    v_exp_f32 v116, v116
    v_exp_f32 v117, v117
    v_smfmac_f32_32x32x32_bf16 v[44:59], v[156:159], v[108:115], v172
    ds_read_b128 v[168:171], v174 offset:1536
    v_exp_f32 v118, v118
    v_exp_f32 v119, v119
    v_exp_f32_e64 v120, v120
    buffer_load_dwordx4 a[172:175], v0, s[4:7], s65 offen offset:3072 sc1
    v_exp_f32 v121, v121
    v_exp_f32 v122, v122
    v_exp_f32 v123, v123
    v_exp_f32 v124, v124
    v_exp_f32_e64 v125, v125
    v_smfmac_f32_32x32x32_bf16 v[44:59], v[164:167], v[116:123], v172
    v_exp_f32 v126, v126
    v_exp_f32 v127, v127
    v_exp_f32 v128, v128
    v_exp_f32 v129, v129
    v_mfma_f32_32x32x16_bf16 v[108:123], v[152:155], v[140:143], v[76:91]
    v_exp_f32 v130, v130
    v_exp_f32 v131, v131
    v_exp_f32 v132, v132
    v_exp_f32 v133, v133
    v_smfmac_f32_32x32x32_bf16 v[60:75], v[156:159], v[124:131], v172
    s_waitcnt lgkmcnt(0)
    v_exp_f32 v134, v134
    v_exp_f32 v135, v135
    v_exp_f32 v136, v136
    buffer_load_dwordx4 a[176:179], v5, s[4:7], s65 offen offset:0 sc1
    v_exp_f32 v137, v137
    v_exp_f32 v138, v138
    v_exp_f32 v139, v139
    v_exp_f32 v108, v108
    v_exp_f32_e64 v109, v109
    v_smfmac_f32_32x32x32_bf16 v[60:75], v[164:167], v[132:139], v172
    v_exp_f32 v110, v110
    v_exp_f32 v111, v111
    v_exp_f32 v112, v112
    v_exp_f32 v113, v113
    v_mfma_f32_32x32x16_bf16 v[124:139], v[152:155], v[144:147], v[92:107]
    ds_read_b128 v[152:155], v173 offset:35840
    v_exp_f32 v114, v114
    v_exp_f32 v115, v115
    ds_read_b128 v[156:159], v174 offset:2048
    v_exp_f32 v116, v116
    v_exp_f32 v117, v117
    v_smfmac_f32_32x32x32_bf16 v[44:59], v[160:163], v[108:115], v172
    ds_read_b128 v[164:167], v174 offset:2560
    v_exp_f32 v118, v118
    v_exp_f32 v119, v119
    v_exp_f32_e64 v120, v120
    buffer_load_dwordx4 a[180:183], v5, s[4:7], s65 offen offset:1024 sc1
    v_exp_f32 v121, v121
    v_exp_f32 v122, v122
    v_exp_f32 v123, v123
    v_exp_f32 v124, v124
    v_exp_f32_e64 v125, v125
    v_smfmac_f32_32x32x32_bf16 v[44:59], v[168:171], v[116:123], v172
    v_exp_f32 v126, v126
    v_exp_f32 v127, v127
    v_exp_f32 v128, v128
    v_exp_f32 v129, v129
    v_mfma_f32_32x32x16_bf16 v[108:123], v[148:151], v[140:143], v[76:91]
    v_exp_f32 v130, v130
    v_exp_f32 v131, v131
    buffer_load_dword v27, v25, s[4:7], s70 offen sc1
    v_exp_f32 v132, v132
    v_exp_f32 v133, v133
    v_smfmac_f32_32x32x32_bf16 v[60:75], v[160:163], v[124:131], v172
    s_waitcnt lgkmcnt(0)
    v_exp_f32 v134, v134
    v_exp_f32 v135, v135
    v_exp_f32 v136, v136
    buffer_load_dwordx4 a[184:187], v5, s[4:7], s65 offen offset:2048 sc1
    v_exp_f32 v137, v137
    v_exp_f32 v138, v138
    v_exp_f32 v139, v139
    v_exp_f32 v108, v108
    v_exp_f32_e64 v109, v109
    v_smfmac_f32_32x32x32_bf16 v[60:75], v[168:171], v[132:139], v172
    v_exp_f32 v110, v110
    v_exp_f32 v111, v111
    v_exp_f32 v112, v112
    v_exp_f32 v113, v113
    v_mfma_f32_32x32x16_bf16 v[124:139], v[148:151], v[144:147], v[92:107]
    ds_read_b128 v[148:151], v173 offset:40960
    v_exp_f32 v114, v114
    v_exp_f32 v115, v115
    ds_read_b128 v[160:163], v174 offset:3072
    v_exp_f32 v116, v116
    v_exp_f32 v117, v117
    v_smfmac_f32_32x32x32_bf16 v[44:59], v[156:159], v[108:115], v172
    ds_read_b128 v[168:171], v174 offset:3584
    v_exp_f32 v118, v118
    v_exp_f32 v119, v119
    v_exp_f32_e64 v120, v120
    buffer_load_dwordx4 a[188:191], v5, s[4:7], s65 offen offset:3072 sc1
    v_exp_f32 v121, v121
    v_exp_f32 v122, v122
    v_exp_f32 v123, v123
    v_exp_f32 v124, v124
    v_exp_f32_e64 v125, v125
    v_smfmac_f32_32x32x32_bf16 v[44:59], v[164:167], v[116:123], v172
    v_exp_f32 v126, v126
    v_exp_f32 v127, v127
    v_exp_f32 v128, v128
    v_exp_f32 v129, v129
    v_mfma_f32_32x32x16_bf16 v[108:123], v[152:155], v[140:143], v[76:91]
    v_exp_f32 v130, v130
    v_exp_f32 v131, v131
    s_add_u32 s94, s49, 2097152
    buffer_load_dword v27, v24, s[4:7], s94 offen sc1
    v_exp_f32 v132, v132
    v_exp_f32 v133, v133
    v_smfmac_f32_32x32x32_bf16 v[60:75], v[156:159], v[124:131], v172
    s_waitcnt lgkmcnt(0)
    v_exp_f32 v134, v134
    v_exp_f32 v135, v135
    v_exp_f32 v136, v136
    buffer_load_dwordx4 a[192:195], v0, s[4:7], s66 offen offset:0 sc1
    v_exp_f32 v137, v137
    v_exp_f32 v138, v138
    v_exp_f32 v139, v139
    v_exp_f32 v108, v108
    v_exp_f32_e64 v109, v109
    v_smfmac_f32_32x32x32_bf16 v[60:75], v[164:167], v[132:139], v172
    v_exp_f32 v110, v110
    v_exp_f32 v111, v111
    v_exp_f32 v112, v112
    v_exp_f32 v113, v113
    v_mfma_f32_32x32x16_bf16 v[124:139], v[152:155], v[144:147], v[92:107]
    ds_read_b128 v[152:155], v173 offset:41984
    v_add_u32 v174, v175, v174
    v_exp_f32 v114, v114
    v_exp_f32_e64 v115, v115
    ds_read_b128 v[156:159], v174 offset:0
    v_exp_f32 v116, v116
    v_exp_f32 v117, v117
    v_smfmac_f32_32x32x32_bf16 v[44:59], v[160:163], v[108:115], v172
    ds_read_b128 v[164:167], v174 offset:512
    v_exp_f32 v118, v118
    v_exp_f32 v119, v119
    v_exp_f32_e64 v120, v120
    buffer_load_dwordx4 a[196:199], v0, s[4:7], s66 offen offset:1024 sc1
    v_exp_f32 v121, v121
    v_exp_f32 v122, v122
    v_exp_f32 v123, v123
    v_exp_f32 v124, v124
    v_exp_f32_e64 v125, v125
    v_smfmac_f32_32x32x32_bf16 v[44:59], v[168:171], v[116:123], v172
    v_exp_f32 v126, v126
    v_exp_f32 v127, v127
    v_exp_f32 v128, v128
    v_exp_f32 v129, v129
    v_mfma_f32_32x32x16_bf16 v[108:123], v[148:151], v[140:143], v[76:91]
    v_exp_f32 v130, v130
    v_exp_f32 v131, v131
    v_exp_f32 v132, v132
    v_exp_f32 v133, v133
    v_smfmac_f32_32x32x32_bf16 v[60:75], v[160:163], v[124:131], v172
    s_waitcnt lgkmcnt(0)
    v_exp_f32 v134, v134
    v_exp_f32 v135, v135
    v_exp_f32 v136, v136
    buffer_load_dwordx4 a[200:203], v0, s[4:7], s66 offen offset:2048 sc1
    v_exp_f32 v137, v137
    v_exp_f32 v138, v138
    v_exp_f32 v139, v139
    v_exp_f32 v108, v108
    v_exp_f32_e64 v109, v109
    v_smfmac_f32_32x32x32_bf16 v[60:75], v[168:171], v[132:139], v172
    v_exp_f32 v110, v110
    v_exp_f32 v111, v111
    v_exp_f32 v112, v112
    v_exp_f32 v113, v113
    v_mfma_f32_32x32x16_bf16 v[124:139], v[148:151], v[144:147], v[92:107]
    ds_read_b128 v[148:151], v173 offset:43008
    v_exp_f32 v114, v114
    v_exp_f32 v115, v115
    ds_read_b128 v[160:163], v174 offset:1024
    v_exp_f32 v116, v116
    v_exp_f32 v117, v117
    v_smfmac_f32_32x32x32_bf16 v[44:59], v[156:159], v[108:115], v172
    ds_read_b128 v[168:171], v174 offset:1536
    v_exp_f32 v118, v118
    v_exp_f32 v119, v119
    v_exp_f32_e64 v120, v120
    buffer_load_dwordx4 a[204:207], v0, s[4:7], s66 offen offset:3072 sc1
    v_exp_f32 v121, v121
    v_exp_f32 v122, v122
    v_exp_f32 v123, v123
    v_exp_f32 v124, v124
    v_exp_f32_e64 v125, v125
    v_smfmac_f32_32x32x32_bf16 v[44:59], v[164:167], v[116:123], v172
    v_exp_f32 v126, v126
    v_exp_f32 v127, v127
    v_exp_f32 v128, v128
    v_exp_f32 v129, v129
    v_mfma_f32_32x32x16_bf16 v[108:123], v[152:155], v[140:143], v[76:91]
    v_exp_f32 v130, v130
    v_exp_f32 v131, v131
    buffer_load_dword v27, v24, s[4:7], s49 offen sc1
    v_exp_f32 v132, v132
    v_exp_f32 v133, v133
    v_smfmac_f32_32x32x32_bf16 v[60:75], v[156:159], v[124:131], v172
    s_waitcnt lgkmcnt(0)
    v_exp_f32 v134, v134
    v_exp_f32 v135, v135
    v_exp_f32 v136, v136
    buffer_load_dwordx4 a[208:211], v5, s[4:7], s66 offen offset:0 sc1
    v_exp_f32 v137, v137
    v_exp_f32 v138, v138
    v_exp_f32 v139, v139
    v_exp_f32 v108, v108
    v_exp_f32_e64 v109, v109
    v_smfmac_f32_32x32x32_bf16 v[60:75], v[164:167], v[132:139], v172
    v_exp_f32 v110, v110
    v_exp_f32 v111, v111
    v_exp_f32 v112, v112
    v_exp_f32 v113, v113
    v_mfma_f32_32x32x16_bf16 v[124:139], v[152:155], v[144:147], v[92:107]
    ds_read_b128 v[152:155], v173 offset:44032
    v_exp_f32 v114, v114
    v_exp_f32 v115, v115
    ds_read_b128 v[156:159], v174 offset:2048
    v_exp_f32 v116, v116
    v_exp_f32 v117, v117
    v_smfmac_f32_32x32x32_bf16 v[44:59], v[160:163], v[108:115], v172
    ds_read_b128 v[164:167], v174 offset:2560
    v_exp_f32 v118, v118
    v_exp_f32 v119, v119
    v_exp_f32_e64 v120, v120
    buffer_load_dwordx4 a[212:215], v5, s[4:7], s66 offen offset:1024 sc1
    v_exp_f32 v121, v121
    v_exp_f32 v122, v122
    v_exp_f32 v123, v123
    v_exp_f32 v124, v124
    v_exp_f32_e64 v125, v125
    v_smfmac_f32_32x32x32_bf16 v[44:59], v[168:171], v[116:123], v172
    v_exp_f32 v126, v126
    v_exp_f32 v127, v127
    v_exp_f32 v128, v128
    v_exp_f32 v129, v129
    v_mfma_f32_32x32x16_bf16 v[108:123], v[148:151], v[140:143], v[76:91]
    v_exp_f32 v130, v130
    v_exp_f32 v131, v131
    v_exp_f32 v132, v132
    v_exp_f32 v133, v133
    v_smfmac_f32_32x32x32_bf16 v[60:75], v[160:163], v[124:131], v172
    s_waitcnt lgkmcnt(0)
    v_exp_f32 v134, v134
    v_exp_f32 v135, v135
    v_exp_f32 v136, v136
    buffer_load_dwordx4 a[216:219], v5, s[4:7], s66 offen offset:2048 sc1
    v_exp_f32 v137, v137
    v_exp_f32 v138, v138
    v_exp_f32 v139, v139
    v_exp_f32 v108, v108
    v_exp_f32_e64 v109, v109
    v_smfmac_f32_32x32x32_bf16 v[60:75], v[168:171], v[132:139], v172
    v_exp_f32 v110, v110
    v_exp_f32 v111, v111
    v_exp_f32 v112, v112
    v_exp_f32 v113, v113
    v_mfma_f32_32x32x16_bf16 v[124:139], v[148:151], v[144:147], v[92:107]
    ds_read_b128 v[148:151], v173 offset:49152
    v_exp_f32 v114, v114
    v_exp_f32 v115, v115
    ds_read_b128 v[160:163], v174 offset:3072
    v_exp_f32 v116, v116
    v_exp_f32 v117, v117
    v_smfmac_f32_32x32x32_bf16 v[44:59], v[156:159], v[108:115], v172
    ds_read_b128 v[168:171], v174 offset:3584
    v_exp_f32 v118, v118
    v_exp_f32 v119, v119
    v_exp_f32_e64 v120, v120
    buffer_load_dwordx4 a[220:223], v5, s[4:7], s66 offen offset:3072 sc1
    v_exp_f32 v121, v121
    v_exp_f32 v122, v122
    v_exp_f32 v123, v123
    v_exp_f32 v124, v124
    v_exp_f32_e64 v125, v125
    v_smfmac_f32_32x32x32_bf16 v[44:59], v[164:167], v[116:123], v172
    v_exp_f32 v126, v126
    v_exp_f32 v127, v127
    v_exp_f32 v128, v128
    v_exp_f32 v129, v129
    v_mfma_f32_32x32x16_bf16 v[108:123], v[152:155], v[140:143], v[76:91]
    v_exp_f32 v130, v130
    v_exp_f32 v131, v131
    buffer_load_dword v27, v24, s[4:7], s71 offen sc1
    v_exp_f32 v132, v132
    v_exp_f32 v133, v133
    v_smfmac_f32_32x32x32_bf16 v[60:75], v[156:159], v[124:131], v172
    s_waitcnt lgkmcnt(0)
    v_exp_f32 v134, v134
    v_exp_f32 v135, v135
    v_exp_f32 v136, v136
    buffer_load_dwordx4 a[224:227], v0, s[4:7], s67 offen offset:0 sc1
    v_exp_f32 v137, v137
    v_exp_f32 v138, v138
    v_exp_f32 v139, v139
    v_exp_f32 v108, v108
    v_exp_f32_e64 v109, v109
    v_smfmac_f32_32x32x32_bf16 v[60:75], v[164:167], v[132:139], v172
    v_exp_f32 v110, v110
    v_exp_f32 v111, v111
    v_exp_f32 v112, v112
    v_exp_f32 v113, v113
    v_mfma_f32_32x32x16_bf16 v[124:139], v[152:155], v[144:147], v[92:107]
    ds_read_b128 v[152:155], v173 offset:50176
    v_add_u32 v174, v175, v174
    v_exp_f32 v114, v114
    v_exp_f32_e64 v115, v115
    ds_read_b128 v[156:159], v174 offset:0
    v_exp_f32 v116, v116
    v_exp_f32 v117, v117
    v_smfmac_f32_32x32x32_bf16 v[44:59], v[160:163], v[108:115], v172
    ds_read_b128 v[164:167], v174 offset:512
    v_exp_f32 v118, v118
    v_exp_f32 v119, v119
    v_exp_f32_e64 v120, v120
    buffer_load_dwordx4 a[228:231], v0, s[4:7], s67 offen offset:1024 sc1
    v_exp_f32 v121, v121
    v_exp_f32 v122, v122
    v_exp_f32 v123, v123
    v_exp_f32 v124, v124
    v_exp_f32_e64 v125, v125
    v_smfmac_f32_32x32x32_bf16 v[44:59], v[168:171], v[116:123], v172
    v_exp_f32 v126, v126
    v_exp_f32 v127, v127
    v_exp_f32 v128, v128
    v_exp_f32 v129, v129
    v_mfma_f32_32x32x16_bf16 v[108:123], v[148:151], v[140:143], v[76:91]
    v_exp_f32 v130, v130
    v_exp_f32 v131, v131
    v_exp_f32 v132, v132
    v_exp_f32 v133, v133
    v_smfmac_f32_32x32x32_bf16 v[60:75], v[160:163], v[124:131], v172
    s_waitcnt lgkmcnt(0)
    v_exp_f32 v134, v134
    v_exp_f32 v135, v135
    v_exp_f32 v136, v136
    buffer_load_dwordx4 a[232:235], v0, s[4:7], s67 offen offset:2048 sc1
    v_exp_f32 v137, v137
    v_exp_f32 v138, v138
    v_exp_f32 v139, v139
    v_exp_f32 v108, v108
    v_exp_f32_e64 v109, v109
    v_smfmac_f32_32x32x32_bf16 v[60:75], v[168:171], v[132:139], v172
    v_exp_f32 v110, v110
    v_exp_f32 v111, v111
    v_exp_f32 v112, v112
    v_exp_f32 v113, v113
    v_mfma_f32_32x32x16_bf16 v[124:139], v[148:151], v[144:147], v[92:107]
    ds_read_b128 v[148:151], v173 offset:51200
    v_exp_f32 v114, v114
    v_exp_f32 v115, v115
    ds_read_b128 v[160:163], v174 offset:1024
    v_exp_f32 v116, v116
    v_exp_f32 v117, v117
    v_smfmac_f32_32x32x32_bf16 v[44:59], v[156:159], v[108:115], v172
    ds_read_b128 v[168:171], v174 offset:1536
    v_exp_f32 v118, v118
    v_exp_f32 v119, v119
    v_exp_f32_e64 v120, v120
    buffer_load_dwordx4 a[236:239], v0, s[4:7], s67 offen offset:3072 sc1
    v_exp_f32 v121, v121
    v_exp_f32 v122, v122
    v_exp_f32 v123, v123
    v_exp_f32 v124, v124
    v_exp_f32_e64 v125, v125
    v_smfmac_f32_32x32x32_bf16 v[44:59], v[164:167], v[116:123], v172
    v_exp_f32 v126, v126
    v_exp_f32 v127, v127
    v_exp_f32 v128, v128
    v_exp_f32 v129, v129
    v_mfma_f32_32x32x16_bf16 v[108:123], v[152:155], v[140:143], v[76:91]
    v_exp_f32 v130, v130
    v_exp_f32 v131, v131
    buffer_load_dword v27, v24, s[4:7], s72 offen sc1
    v_exp_f32 v132, v132
    v_exp_f32 v133, v133
    v_smfmac_f32_32x32x32_bf16 v[60:75], v[156:159], v[124:131], v172
    s_waitcnt lgkmcnt(0)
    v_exp_f32 v134, v134
    v_exp_f32 v135, v135
    v_exp_f32 v136, v136
    buffer_load_dwordx4 a[240:243], v5, s[4:7], s67 offen offset:0 sc1
    v_exp_f32 v137, v137
    v_exp_f32 v138, v138
    v_exp_f32 v139, v139
    v_exp_f32 v108, v108
    v_exp_f32_e64 v109, v109
    v_smfmac_f32_32x32x32_bf16 v[60:75], v[164:167], v[132:139], v172
    v_exp_f32 v110, v110
    v_exp_f32 v111, v111
    v_exp_f32 v112, v112
    v_exp_f32 v113, v113
    v_mfma_f32_32x32x16_bf16 v[124:139], v[152:155], v[144:147], v[92:107]
    ds_read_b128 v[152:155], v173 offset:52224
    v_exp_f32 v114, v114
    v_exp_f32 v115, v115
    ds_read_b128 v[156:159], v174 offset:2048
    v_exp_f32 v116, v116
    v_exp_f32 v117, v117
    v_smfmac_f32_32x32x32_bf16 v[44:59], v[160:163], v[108:115], v172
    ds_read_b128 v[164:167], v174 offset:2560
    v_exp_f32 v118, v118
    v_exp_f32 v119, v119
    v_exp_f32_e64 v120, v120
    buffer_load_dwordx4 a[244:247], v5, s[4:7], s67 offen offset:1024 sc1
    v_exp_f32 v121, v121
    v_exp_f32 v122, v122
    v_exp_f32 v123, v123
    v_exp_f32 v124, v124
    v_exp_f32_e64 v125, v125
    v_smfmac_f32_32x32x32_bf16 v[44:59], v[168:171], v[116:123], v172
    v_exp_f32 v126, v126
    v_exp_f32 v127, v127
    v_exp_f32 v128, v128
    v_exp_f32 v129, v129
    v_mfma_f32_32x32x16_bf16 v[108:123], v[148:151], v[140:143], v[76:91]
    v_exp_f32 v130, v130
    v_exp_f32 v131, v131
    v_exp_f32 v132, v132
    v_exp_f32 v133, v133
    v_smfmac_f32_32x32x32_bf16 v[60:75], v[160:163], v[124:131], v172
    s_waitcnt lgkmcnt(0)
    v_exp_f32 v134, v134
    v_exp_f32 v135, v135
    v_exp_f32 v136, v136
    buffer_load_dwordx4 a[248:251], v5, s[4:7], s67 offen offset:2048 sc1
    v_exp_f32 v137, v137
    v_exp_f32 v138, v138
    v_exp_f32 v139, v139
    v_exp_f32 v108, v108
    v_exp_f32_e64 v109, v109
    v_smfmac_f32_32x32x32_bf16 v[60:75], v[168:171], v[132:139], v172
    v_exp_f32 v110, v110
    v_exp_f32 v111, v111
    v_exp_f32 v112, v112
    v_exp_f32 v113, v113
    v_mfma_f32_32x32x16_bf16 v[124:139], v[148:151], v[144:147], v[92:107]
    ds_read_b128 v[148:151], v173 offset:57344
    v_exp_f32 v114, v114
    v_exp_f32 v115, v115
    ds_read_b128 v[160:163], v174 offset:3072
    v_exp_f32 v116, v116
    v_exp_f32 v117, v117
    v_smfmac_f32_32x32x32_bf16 v[44:59], v[156:159], v[108:115], v172
    ds_read_b128 v[168:171], v174 offset:3584
    v_exp_f32 v118, v118
    v_exp_f32 v119, v119
    v_exp_f32_e64 v120, v120
    buffer_load_dwordx4 a[252:255], v5, s[4:7], s67 offen offset:3072 sc1
    v_exp_f32 v121, v121
    v_exp_f32 v122, v122
    v_exp_f32 v123, v123
    v_exp_f32 v124, v124
    v_exp_f32_e64 v125, v125
    v_smfmac_f32_32x32x32_bf16 v[44:59], v[164:167], v[116:123], v172
    v_exp_f32 v126, v126
    v_exp_f32 v127, v127
    v_exp_f32 v128, v128
    v_exp_f32 v129, v129
    v_mfma_f32_32x32x16_bf16 v[108:123], v[152:155], v[140:143], v[76:91]
    v_exp_f32 v130, v130
    v_exp_f32 v131, v131
    s_add_u32 s94, s71, 114688
    buffer_load_dword v27, v24, s[4:7], s94 offen sc1
    v_exp_f32 v132, v132
    v_exp_f32 v133, v133
    v_smfmac_f32_32x32x32_bf16 v[60:75], v[156:159], v[124:131], v172
    s_waitcnt lgkmcnt(0)
    v_exp_f32 v134, v134
    v_exp_f32 v135, v135
    v_exp_f32 v136, v136
    buffer_load_dwordx4 v[248:251], v0, s[4:7], s68 offen offset:0 sc1
    v_exp_f32 v137, v137
    v_exp_f32 v138, v138
    v_exp_f32 v139, v139
    v_exp_f32 v108, v108
    v_exp_f32_e64 v109, v109
    v_smfmac_f32_32x32x32_bf16 v[60:75], v[164:167], v[132:139], v172
    v_exp_f32 v110, v110
    v_exp_f32 v111, v111
    v_exp_f32 v112, v112
    v_exp_f32 v113, v113
    v_mfma_f32_32x32x16_bf16 v[124:139], v[152:155], v[144:147], v[92:107]
    s_and_b32 s94, s20, 3
    s_lshl_b32 s94, s94, 15
    s_add_u32 s94, s94, s74
    buffer_load_dword v27, v30, s[8:11], s94 offen
    ds_read_b128 v[152:155], v173 offset:58368
    v_add_u32 v174, v175, v174
    v_exp_f32 v114, v114
    v_exp_f32 v115, v115
    ds_read_b128 v[156:159], v174 offset:0
    v_exp_f32 v116, v116
    v_exp_f32 v117, v117
    v_smfmac_f32_32x32x32_bf16 v[44:59], v[160:163], v[108:115], v172
    ds_read_b128 v[164:167], v174 offset:512
    v_exp_f32 v118, v118
    v_exp_f32 v119, v119
    v_exp_f32 v120, v120
    v_exp_f32 v121, v121
    v_exp_f32 v122, v122
    v_exp_f32 v123, v123
    v_exp_f32 v124, v124
    v_exp_f32 v125, v125
    v_smfmac_f32_32x32x32_bf16 v[44:59], v[168:171], v[116:123], v172
    v_exp_f32 v126, v126
    v_exp_f32 v127, v127
    v_exp_f32 v128, v128
    v_exp_f32 v129, v129
    v_mfma_f32_32x32x16_bf16 v[108:123], v[148:151], v[140:143], v[76:91]
    v_exp_f32 v130, v130
    v_exp_f32 v131, v131
    v_exp_f32 v132, v132
    v_exp_f32 v133, v133
    v_smfmac_f32_32x32x32_bf16 v[60:75], v[160:163], v[124:131], v172
    s_waitcnt lgkmcnt(0)
    v_exp_f32 v134, v134
    v_exp_f32 v135, v135
    v_exp_f32 v136, v136
    v_exp_f32 v137, v137
    v_exp_f32 v138, v138
    v_exp_f32 v139, v139
    v_exp_f32 v108, v108
    v_exp_f32_e64 v109, v109
    v_smfmac_f32_32x32x32_bf16 v[60:75], v[168:171], v[132:139], v172
    v_exp_f32 v110, v110
    v_exp_f32 v111, v111
    v_exp_f32 v112, v112
    v_exp_f32 v113, v113
    v_mfma_f32_32x32x16_bf16 v[124:139], v[148:151], v[144:147], v[92:107]
    ds_read_b128 v[148:151], v173 offset:59392
    v_exp_f32 v114, v114
    v_exp_f32 v115, v115
    ds_read_b128 v[160:163], v174 offset:1024
    v_exp_f32 v116, v116
    v_exp_f32 v117, v117
    v_smfmac_f32_32x32x32_bf16 v[44:59], v[156:159], v[108:115], v172
    ds_read_b128 v[168:171], v174 offset:1536
    v_exp_f32 v118, v118
    v_exp_f32 v119, v119
    v_exp_f32 v120, v120
    v_exp_f32 v121, v121
    v_exp_f32 v122, v122
    v_exp_f32 v123, v123
    v_exp_f32 v124, v124
    v_exp_f32 v125, v125
    v_smfmac_f32_32x32x32_bf16 v[44:59], v[164:167], v[116:123], v172
    v_exp_f32 v126, v126
    v_exp_f32 v127, v127
    v_exp_f32 v128, v128
    v_exp_f32 v129, v129
    v_mfma_f32_32x32x16_bf16 v[108:123], v[152:155], v[140:143], v[76:91]
    v_exp_f32 v130, v130
    v_exp_f32 v131, v131
    s_add_u32 s94, s72, 114688
    buffer_load_dword v27, v24, s[4:7], s94 offen sc1
    v_exp_f32 v132, v132
    v_exp_f32 v133, v133
    v_smfmac_f32_32x32x32_bf16 v[60:75], v[156:159], v[124:131], v172
    s_waitcnt lgkmcnt(0)
    v_exp_f32 v134, v134
    v_exp_f32 v135, v135
    v_exp_f32 v136, v136
    v_exp_f32 v137, v137
    v_exp_f32 v138, v138
    v_exp_f32 v139, v139
    v_exp_f32 v108, v108
    v_exp_f32_e64 v109, v109
    v_smfmac_f32_32x32x32_bf16 v[60:75], v[164:167], v[132:139], v172
    v_exp_f32 v110, v110
    v_exp_f32 v111, v111
    v_exp_f32 v112, v112
    v_exp_f32 v113, v113
    v_mfma_f32_32x32x16_bf16 v[124:139], v[152:155], v[144:147], v[92:107]
    ds_read_b128 v[152:155], v173 offset:60416
    v_exp_f32 v114, v114
    v_exp_f32 v115, v115
    ds_read_b128 v[156:159], v174 offset:2048
    v_exp_f32 v116, v116
    v_exp_f32 v117, v117
    v_smfmac_f32_32x32x32_bf16 v[44:59], v[160:163], v[108:115], v172
    ds_read_b128 v[164:167], v174 offset:2560
    v_exp_f32 v118, v118
    v_exp_f32 v119, v119
    v_exp_f32 v120, v120
    v_exp_f32 v121, v121
    v_exp_f32 v122, v122
    v_exp_f32 v123, v123
    v_exp_f32 v124, v124
    v_exp_f32 v125, v125
    v_smfmac_f32_32x32x32_bf16 v[44:59], v[168:171], v[116:123], v172
    v_exp_f32 v126, v126
    v_exp_f32 v127, v127
    v_exp_f32 v128, v128
    v_exp_f32 v129, v129
    v_mfma_f32_32x32x16_bf16 v[108:123], v[148:151], v[140:143], v[76:91]
    v_exp_f32 v130, v130
    v_exp_f32 v131, v131
    v_exp_f32 v132, v132
    v_exp_f32 v133, v133
    v_smfmac_f32_32x32x32_bf16 v[60:75], v[160:163], v[124:131], v172
    s_waitcnt lgkmcnt(0)
    v_exp_f32 v134, v134
    v_exp_f32 v135, v135
    v_exp_f32 v136, v136
    v_exp_f32 v137, v137
    v_exp_f32 v138, v138
    v_exp_f32 v139, v139
    v_exp_f32 v108, v108
    v_exp_f32_e64 v109, v109
    v_smfmac_f32_32x32x32_bf16 v[60:75], v[168:171], v[132:139], v172
    v_exp_f32 v110, v110
    v_exp_f32 v111, v111
    v_exp_f32 v112, v112
    v_exp_f32 v113, v113
    v_mfma_f32_32x32x16_bf16 v[124:139], v[148:151], v[144:147], v[92:107]
    v_exp_f32 v114, v114
    v_exp_f32 v115, v115
    ds_read_b128 v[160:163], v174 offset:3072
    v_exp_f32 v116, v116
    v_exp_f32 v117, v117
    v_smfmac_f32_32x32x32_bf16 v[44:59], v[156:159], v[108:115], v172
    ds_read_b128 v[168:171], v174 offset:3584
    v_exp_f32 v118, v118
    v_exp_f32 v119, v119
    v_exp_f32 v120, v120
    v_exp_f32 v121, v121
    v_exp_f32 v122, v122
    v_exp_f32 v123, v123
    v_exp_f32 v124, v124
    v_exp_f32 v125, v125
    v_smfmac_f32_32x32x32_bf16 v[44:59], v[164:167], v[116:123], v172
    v_exp_f32 v126, v126
    v_exp_f32 v127, v127
    v_exp_f32 v128, v128
    v_exp_f32 v129, v129
    v_mfma_f32_32x32x16_bf16 v[108:123], v[152:155], v[140:143], v[76:91]
    v_exp_f32 v130, v130
    v_exp_f32 v131, v131
    v_exp_f32 v132, v132
    v_exp_f32 v133, v133
    v_smfmac_f32_32x32x32_bf16 v[60:75], v[156:159], v[124:131], v172
    s_waitcnt lgkmcnt(0)
    v_exp_f32 v134, v134
    v_exp_f32 v135, v135
    v_exp_f32 v136, v136
    v_exp_f32 v137, v137
    v_exp_f32 v138, v138
    v_exp_f32 v139, v139
    v_exp_f32 v108, v108
    v_exp_f32_e64 v109, v109
    v_smfmac_f32_32x32x32_bf16 v[60:75], v[164:167], v[132:139], v172
    v_exp_f32 v110, v110
    v_exp_f32 v111, v111
    v_exp_f32 v112, v112
    v_exp_f32 v113, v113
    v_mfma_f32_32x32x16_bf16 v[124:139], v[152:155], v[144:147], v[92:107]
    v_exp_f32 v114, v114
    v_exp_f32 v115, v115
    v_exp_f32 v116, v116
    v_exp_f32 v117, v117
    v_smfmac_f32_32x32x32_bf16 v[44:59], v[160:163], v[108:115], v172
    v_exp_f32 v118, v118
    v_exp_f32 v119, v119
    v_exp_f32 v120, v120
    v_exp_f32 v121, v121
    v_exp_f32 v122, v122
    v_exp_f32 v123, v123
    s_nop 0
    v_exp_f32 v124, v124
    v_exp_f32 v125, v125
    v_smfmac_f32_32x32x32_bf16 v[44:59], v[168:171], v[116:123], v172
    v_exp_f32 v126, v126
    v_exp_f32 v127, v127
    v_exp_f32 v128, v128
    v_exp_f32 v129, v129
    v_exp_f32 v130, v130
    v_exp_f32 v131, v131
    v_exp_f32 v132, v132
    v_exp_f32 v133, v133
    v_smfmac_f32_32x32x32_bf16 v[60:75], v[160:163], v[124:131], v172
    s_waitcnt lgkmcnt(0)
    v_exp_f32 v134, v134
    v_exp_f32 v135, v135
    v_exp_f32 v136, v136
    v_exp_f32 v137, v137
    v_exp_f32 v138, v138
    v_exp_f32 v139, v139
L_att_fin:
    s_nop 1
    v_smfmac_f32_32x32x32_bf16 v[60:75], v[168:171], v[132:139], v172
    v_readfirstlane_b32 s24, v179
    v_rcp_f32 v108, v52
    s_add_u32 s97, s49, 2097152
    v_mul_f32 v44, v108, v44
    v_mul_f32 v45, v108, v45
    v_mul_f32 v46, v108, v46
    v_mul_f32 v47, v108, v47
    v_mul_f32 v48, v108, v48
    v_mul_f32 v49, v108, v49
    v_mul_f32 v50, v108, v50
    v_mul_f32 v51, v108, v51
    v_cvt_pk_bf16_f32 v112, v44, v45
    v_cvt_pk_bf16_f32 v113, v46, v47
    v_cvt_pk_bf16_f32 v114, v48, v49
    v_cvt_pk_bf16_f32 v115, v50, v51
    v_rcp_f32 v109, v68
    s_nop 0
    v_mul_f32 v60, v109, v60
    v_mul_f32 v61, v109, v61
    v_mul_f32 v62, v109, v62
    v_mul_f32 v63, v109, v63
    v_mul_f32 v64, v109, v64
    v_mul_f32 v65, v109, v65
    v_mul_f32 v66, v109, v66
    v_mul_f32 v67, v109, v67
    v_cvt_pk_bf16_f32 v116, v60, v61
    v_cvt_pk_bf16_f32 v117, v62, v63
    v_cvt_pk_bf16_f32 v118, v64, v65
    v_cvt_pk_bf16_f32 v119, v66, v67
    s_cmp_eq_u32 s24, 0
    s_cbranch_scc1 L_slow_10
    buffer_store_dwordx4 v[112:115], v0, s[4:7], s97 offen offset:0
    buffer_store_dwordx4 v[116:119], v0, s[4:7], s97 offen offset:1024
L_join_11:
    v_mul_f32 v110, 0x5f800000, v52
    v_mul_f32 v111, 0x5f800000, v68
    v_mul_f32 v110, 0, v110
    v_fma_f32 v110, v111, 0, v110
    v_mul_f32 v111, 0x61800000, v108
    v_fma_f32 v110, v111, 0, v110
    v_mul_f32 v111, 0x61800000, v109
    v_fma_f32 v110, v111, 0, v110
    v_fma_f32 v110, v44, 0, v110
    v_fma_f32 v110, v60, 0, v110
    v_fma_f32 v110, v45, 0, v110
    v_fma_f32 v110, v61, 0, v110
    v_fma_f32 v110, v46, 0, v110
    v_fma_f32 v110, v62, 0, v110
    v_fma_f32 v110, v47, 0, v110
    v_fma_f32 v110, v63, 0, v110
    v_fma_f32 v110, v48, 0, v110
    v_fma_f32 v110, v64, 0, v110
    v_fma_f32 v110, v49, 0, v110
    v_fma_f32 v110, v65, 0, v110
    v_fma_f32 v110, v50, 0, v110
    v_fma_f32 v110, v66, 0, v110
    v_fma_f32 v110, v51, 0, v110
    v_fma_f32 v110, v67, 0, v110
    v_cmp_u_f32 vcc, v110, v110
    s_cbranch_vccnz L_att_retry
L_att_ok:
    s_add_u32 s98, s51, 2097152
    s_add_u32 s99, s52, 2097152
    s_waitcnt vmcnt(0)
    s_cmp_eq_u32 s24, 0
    s_cbranch_scc1 L_slow_12
    s_mov_b64 exec, 1
    buffer_store_dword v36, off, s[4:7], s30 offset:128
    s_mov_b64 exec, -1
L_join_13:
    s_add_u32 s92, s69, 0
    buffer_load_dwordx4 v[172:175], v0, s[4:7], s92 offen offset:3072 sc1
    s_add_u32 s93, s70, 0
    buffer_load_dwordx4 v[176:179], v0, s[4:7], s93 offen offset:3072 sc1
    buffer_load_dword v3, v2, s[4:7], s31 offen offset:128 sc1
    s_waitcnt vmcnt(0)
    v_xor_b32 v3, s23, v3
    v_cmp_lt_u32 vcc, 7, v3
    s_nop 0
    s_and_b64 vcc, vcc, s[34:35]
    s_cbranch_scc1 L_spin_14
L_back_15:
    buffer_load_dwordx4 v[108:111], v0, s[4:7], s98 offen offset:0 sc1
    buffer_load_dwordx4 v[112:115], v0, s[4:7], s98 offen offset:1024 sc1
    buffer_load_dwordx4 v[116:119], v0, s[4:7], s98 offen offset:2048 sc1
    buffer_load_dwordx4 v[120:123], v0, s[4:7], s98 offen offset:3072 sc1
    buffer_load_dwordx4 v[124:127], v5, s[4:7], s98 offen offset:0 sc1
    buffer_load_dwordx4 v[128:131], v5, s[4:7], s98 offen offset:1024 sc1
    buffer_load_dwordx4 v[132:135], v5, s[4:7], s98 offen offset:2048 sc1
    buffer_load_dwordx4 v[136:139], v5, s[4:7], s98 offen offset:3072 sc1
    buffer_load_dwordx4 v[140:143], v0, s[4:7], s99 offen offset:0 sc1
    buffer_load_dwordx4 v[144:147], v0, s[4:7], s99 offen offset:1024 sc1
    buffer_load_dwordx4 v[148:151], v0, s[4:7], s99 offen offset:2048 sc1
    buffer_load_dwordx4 v[152:155], v0, s[4:7], s99 offen offset:3072 sc1
    buffer_load_dwordx4 v[156:159], v5, s[4:7], s99 offen offset:0 sc1
    buffer_load_dwordx4 v[160:163], v5, s[4:7], s99 offen offset:1024 sc1
    buffer_load_dwordx4 v[164:167], v5, s[4:7], s99 offen offset:2048 sc1
    buffer_load_dwordx4 v[168:171], v5, s[4:7], s99 offen offset:3072 sc1
    s_waitcnt vmcnt(15)
    v_mfma_f32_32x32x16_bf16 v[44:59], v[180:183], v[108:111], 0
    v_mfma_f32_32x32x16_bf16 v[60:75], v[184:187], v[108:111], 0
    s_waitcnt vmcnt(14)
    v_mfma_f32_32x32x16_bf16 v[44:59], v[188:191], v[112:115], v[44:59]
    v_mfma_f32_32x32x16_bf16 v[60:75], v[192:195], v[112:115], v[60:75]
    s_waitcnt vmcnt(13)
    v_mfma_f32_32x32x16_bf16 v[44:59], v[196:199], v[116:119], v[44:59]
    v_mfma_f32_32x32x16_bf16 v[60:75], v[200:203], v[116:119], v[60:75]
    s_waitcnt vmcnt(12)
    v_mfma_f32_32x32x16_bf16 v[44:59], v[204:207], v[120:123], v[44:59]
    v_mfma_f32_32x32x16_bf16 v[60:75], v[208:211], v[120:123], v[60:75]
    s_waitcnt vmcnt(11)
    v_mfma_f32_32x32x16_bf16 v[44:59], v[212:215], v[124:127], v[44:59]
    v_mfma_f32_32x32x16_bf16 v[60:75], v[216:219], v[124:127], v[60:75]
    s_waitcnt vmcnt(10)
    v_mfma_f32_32x32x16_bf16 v[44:59], v[220:223], v[128:131], v[44:59]
    v_mfma_f32_32x32x16_bf16 v[60:75], v[224:227], v[128:131], v[60:75]
    s_waitcnt vmcnt(9)
    v_mfma_f32_32x32x16_bf16 v[44:59], v[228:231], v[132:135], v[44:59]
    v_mfma_f32_32x32x16_bf16 v[60:75], v[232:235], v[132:135], v[60:75]
    s_waitcnt vmcnt(8)
    v_mfma_f32_32x32x16_bf16 v[44:59], v[236:239], v[136:139], v[44:59]
    v_mfma_f32_32x32x16_bf16 v[60:75], v[240:243], v[136:139], v[60:75]
    s_waitcnt vmcnt(7)
    v_mfma_f32_32x32x16_bf16 v[76:91], v[180:183], v[140:143], 0
    buffer_load_dwordx4 v[180:183], v5, s[4:7], s92 offen offset:0 sc1
    s_waitcnt vmcnt(7)
    v_mfma_f32_32x32x16_bf16 v[76:91], v[188:191], v[144:147], v[76:91]
    buffer_load_dwordx4 v[188:191], v5, s[4:7], s92 offen offset:1024 sc1
    s_nop 4
    ds_write_b128 v42, v[44:47] offset:0
    s_waitcnt vmcnt(7)
    v_mfma_f32_32x32x16_bf16 v[76:91], v[196:199], v[148:151], v[76:91]
    buffer_load_dwordx4 v[196:199], v5, s[4:7], s92 offen offset:2048 sc1
    ds_write_b128 v42, v[48:51] offset:1024
    ds_write_b128 v42, v[52:55] offset:2048
    s_waitcnt vmcnt(7)
    v_mfma_f32_32x32x16_bf16 v[76:91], v[204:207], v[152:155], v[76:91]
    v_mfma_f32_32x32x16_bf16 v[92:107], v[184:187], v[140:143], v[8:23]
    buffer_load_dwordx4 v[204:207], v5, s[4:7], s92 offen offset:3072 sc1
    buffer_load_dwordx4 v[184:187], v5, s[4:7], s93 offen offset:0 sc1
    ds_write_b128 v42, v[56:59] offset:3072
    ds_write_b128 v41, v[60:63] offset:0
    s_waitcnt vmcnt(8)
    v_mfma_f32_32x32x16_bf16 v[76:91], v[212:215], v[156:159], v[76:91]
    v_mfma_f32_32x32x16_bf16 v[92:107], v[192:195], v[144:147], v[92:107]
    s_add_u32 s92, s69, 8192
    buffer_load_dwordx4 v[212:215], v0, s[4:7], s92 offen offset:0 sc1
    buffer_load_dwordx4 v[192:195], v5, s[4:7], s93 offen offset:1024 sc1
    ds_write_b128 v41, v[64:67] offset:1024
    ds_write_b128 v41, v[68:71] offset:2048
    s_waitcnt vmcnt(9)
    v_mfma_f32_32x32x16_bf16 v[76:91], v[220:223], v[160:163], v[76:91]
    v_mfma_f32_32x32x16_bf16 v[92:107], v[200:203], v[148:151], v[92:107]
    buffer_load_dwordx4 v[220:223], v0, s[4:7], s92 offen offset:1024 sc1
    buffer_load_dwordx4 v[200:203], v5, s[4:7], s93 offen offset:2048 sc1
    ds_write_b128 v41, v[72:75] offset:3072
    s_waitcnt vmcnt(10)
    v_mfma_f32_32x32x16_bf16 v[76:91], v[228:231], v[164:167], v[76:91]
    v_mfma_f32_32x32x16_bf16 v[92:107], v[208:211], v[152:155], v[92:107]
    buffer_load_dwordx4 v[228:231], v0, s[4:7], s92 offen offset:2048 sc1
    buffer_load_dwordx4 v[208:211], v5, s[4:7], s93 offen offset:3072 sc1
    s_waitcnt vmcnt(11)
    v_mfma_f32_32x32x16_bf16 v[76:91], v[236:239], v[168:171], v[76:91]
    v_mfma_f32_32x32x16_bf16 v[92:107], v[216:219], v[156:159], v[92:107]
    buffer_load_dwordx4 v[236:239], v0, s[4:7], s92 offen offset:3072 sc1
    s_add_u32 s93, s70, 8192
    buffer_load_dwordx4 v[216:219], v0, s[4:7], s93 offen offset:0 sc1
    s_waitcnt lgkmcnt(0)
    s_barrier
    ds_read_b128 v[108:111], v6 offset:4096
    ds_read_b128 v[112:115], v6 offset:5120
    ds_read_b128 v[116:119], v6 offset:6144
    v_mfma_f32_32x32x16_bf16 v[92:107], v[224:227], v[160:163], v[92:107]
    buffer_load_dwordx4 v[224:227], v0, s[4:7], s93 offen offset:1024 sc1
    ds_read_b128 v[120:123], v6 offset:7168
    ds_read_b128 v[124:127], v6 offset:8192
    ds_read_b128 v[128:131], v6 offset:9216
    v_mfma_f32_32x32x16_bf16 v[92:107], v[232:235], v[164:167], v[92:107]
    buffer_load_dwordx4 v[232:235], v0, s[4:7], s93 offen offset:2048 sc1
    ds_read_b128 v[132:135], v6 offset:10240
    ds_read_b128 v[136:139], v6 offset:11264
    v_mfma_f32_32x32x16_bf16 v[92:107], v[240:243], v[168:171], v[92:107]
    buffer_load_dwordx4 v[240:243], v0, s[4:7], s93 offen offset:3072 sc1
    ds_write_b128 v40, v[76:79] offset:0
    ds_write_b128 v40, v[80:83] offset:1024
    ds_write_b128 v40, v[84:87] offset:2048
    ds_write_b128 v40, v[88:91] offset:3072
    s_waitcnt lgkmcnt(4)
    v_pk_add_f32 v[108:109], v[108:109], v[124:125]
    v_pk_add_f32 v[110:111], v[110:111], v[126:127]
    v_pk_add_f32 v[112:113], v[112:113], v[128:129]
    v_pk_add_f32 v[114:115], v[114:115], v[130:131]
    v_pk_add_f32 v[116:117], v[116:117], v[132:133]
    v_pk_add_f32 v[118:119], v[118:119], v[134:135]
    v_pk_add_f32 v[120:121], v[120:121], v[136:137]
    v_pk_add_f32 v[122:123], v[122:123], v[138:139]
    s_waitcnt lgkmcnt(0)
    s_barrier
    ds_read_b128 v[124:127], v6 offset:0
    ds_read_b128 v[128:131], v6 offset:1024
    ds_read_b128 v[132:135], v6 offset:2048
    ds_read_b128 v[136:139], v6 offset:3072
    v_pk_add_f32 v[108:109], v[108:109], v[92:93]
    v_pk_add_f32 v[110:111], v[110:111], v[94:95]
    v_pk_add_f32 v[112:113], v[112:113], v[96:97]
    v_pk_add_f32 v[114:115], v[114:115], v[98:99]
    v_pk_add_f32 v[116:117], v[116:117], v[100:101]
    v_pk_add_f32 v[118:119], v[118:119], v[102:103]
    v_pk_add_f32 v[120:121], v[120:121], v[104:105]
    v_pk_add_f32 v[122:123], v[122:123], v[106:107]
    s_waitcnt lgkmcnt(3)
    v_pk_add_f32 v[8:9], v[108:109], v[124:125]
    v_pk_add_f32 v[10:11], v[110:111], v[126:127]
    s_waitcnt lgkmcnt(2)
    v_pk_add_f32 v[12:13], v[112:113], v[128:129]
    v_pk_add_f32 v[14:15], v[114:115], v[130:131]
    s_waitcnt lgkmcnt(1)
    v_pk_add_f32 v[16:17], v[116:117], v[132:133]
    v_pk_add_f32 v[18:19], v[118:119], v[134:135]
    s_waitcnt lgkmcnt(0)
    v_pk_add_f32 v[20:21], v[120:121], v[136:137]
    v_pk_add_f32 v[22:23], v[122:123], v[138:139]
    v_cvt_pk_bf16_f32 v44, v8, v9
    v_cvt_pk_bf16_f32 v45, v10, v11
    v_cvt_pk_bf16_f32 v46, v12, v13
    v_cvt_pk_bf16_f32 v47, v14, v15
    v_cvt_pk_bf16_f32 v48, v16, v17
    v_cvt_pk_bf16_f32 v49, v18, v19
    v_cvt_pk_bf16_f32 v50, v20, v21
    v_cvt_pk_bf16_f32 v51, v22, v23
    v_permlane32_swap_b32 v44, v46
    v_permlane32_swap_b32 v45, v47
    v_permlane32_swap_b32 v48, v50
    v_permlane32_swap_b32 v49, v51
    s_cmp_eq_u32 s24, 0
    s_cbranch_scc1 L_slow_16
    buffer_store_dwordx4 v[44:47], v0, s[4:7], s49 offen offset:0
    buffer_store_dwordx4 v[48:51], v0, s[4:7], s49 offen offset:1024
    v_dot2_f32_bf16 v52, v44, s29, 0
    v_dot2_f32_bf16 v53, v44, v44, 0
    v_dot2_f32_bf16 v52, v45, s29, v52
    v_dot2_f32_bf16 v53, v45, v45, v53
    v_dot2_f32_bf16 v52, v46, s29, v52
    v_dot2_f32_bf16 v53, v46, v46, v53
    v_dot2_f32_bf16 v52, v47, s29, v52
    v_dot2_f32_bf16 v53, v47, v47, v53
    v_dot2_f32_bf16 v52, v48, s29, v52
    v_dot2_f32_bf16 v53, v48, v48, v53
    v_dot2_f32_bf16 v52, v49, s29, v52
    v_dot2_f32_bf16 v53, v49, v49, v53
    v_dot2_f32_bf16 v52, v50, s29, v52
    v_dot2_f32_bf16 v53, v50, v50, v53
    v_dot2_f32_bf16 v52, v51, s29, v52
    v_dot2_f32_bf16 v53, v51, v51, v53
    s_nop 2
    v_permlane32_swap_b32 v52, v53
    v_add_f32 v52, v52, v53
    buffer_store_dword v52, v4, s[4:7], s50 offen
    s_waitcnt vmcnt(0)
    s_mov_b64 exec, 1
    buffer_store_dword v36, off, s[4:7], s30 offset:256
    s_mov_b64 exec, -1
L_join_17:
    s_add_u32 s92, s69, 0
    buffer_load_dwordx4 v[148:151], v0, s[4:7], s92 offen offset:0 sc1
    s_add_u32 s93, s70, 0
    buffer_load_dwordx4 v[152:155], v0, s[4:7], s93 offen offset:0 sc1
    buffer_load_dwordx4 v[156:159], v0, s[4:7], s92 offen offset:1024 sc1
    buffer_load_dwordx4 v[160:163], v0, s[4:7], s93 offen offset:1024 sc1
    buffer_load_dwordx4 v[164:167], v0, s[4:7], s92 offen offset:2048 sc1
    buffer_load_dwordx4 v[168:171], v0, s[4:7], s93 offen offset:2048 sc1
    buffer_load_dword v3, v2, s[4:7], s31 offen offset:256 sc1
    s_and_b32 s98, s52, 4294934527
    s_lshl_b32 s97, s22, 13
    s_and_b32 s99, s79, -1024
    s_lshl_b32 s96, s22, 11
    s_add_u32 s99, s99, s96
    s_add_u32 m0, s96, 65536
    s_waitcnt vmcnt(0)
    v_xor_b32 v3, s23, v3
    v_cmp_lt_u32 vcc, 7, v3
    s_nop 0
    s_and_b64 vcc, vcc, s[34:35]
    s_cbranch_scc1 L_spin_18
L_back_19:
    buffer_load_dwordx4 v0, s[4:7], s99 offen offset:0 sc1 lds
    buffer_load_dwordx4 v0, s[4:7], s99 offen offset:1024 sc1 lds
    s_mov_b32 m0, s97
    s_nop 0
    buffer_load_dwordx4 v0, s[4:7], s98 offen offset:0 sc1 lds
    buffer_load_dwordx4 v0, s[4:7], s98 offen offset:1024 sc1 lds
    buffer_load_dwordx4 v0, s[4:7], s98 offen offset:2048 sc1 lds
    buffer_load_dwordx4 v0, s[4:7], s98 offen offset:3072 sc1 lds
    s_add_u32 m0, m0, 4096
    s_add_u32 s98, s98, 4096
    buffer_load_dwordx4 v0, s[4:7], s98 offen offset:0 sc1 lds
    buffer_load_dwordx4 v0, s[4:7], s98 offen offset:1024 sc1 lds
    buffer_load_dwordx4 v0, s[4:7], s98 offen offset:2048 sc1 lds
    buffer_load_dwordx4 v0, s[4:7], s98 offen offset:3072 sc1 lds
    v_mov_b32 v33, 0
    v_add_u32 v3, 65536, v0
    v_cmp_ne_u32 vcc, s25, v33
    s_waitcnt vmcnt(4)
    s_barrier
    ds_read_b128 v[108:111], v0 offset:0
    ds_read_b128 v[112:115], v0 offset:1024
    ds_read_b128 v[116:119], v0 offset:2048
    ds_read_b128 v[120:123], v0 offset:3072
    ds_read_b128 v[76:79], v3 offset:0
    ds_read_b128 v[80:83], v3 offset:1024
    s_waitcnt lgkmcnt(4)
    v_mfma_f32_32x32x16_bf16 v[44:59], a[0:3], v[108:111], 0
    ds_read_b128 v[124:127], v0 offset:8192
    s_add_u32 m0, s97, 32768
    s_add_u32 s98, s98, 28672
    buffer_load_dwordx4 v0, s[4:7], s98 offen offset:0 sc1 lds
    ds_read_b128 v[84:87], v3 offset:2048
    v_mfma_f32_32x32x16_bf16 v[44:59], a[4:7], v[112:115], v[44:59]
    ds_read_b128 v[128:131], v0 offset:9216
    buffer_load_dwordx4 v0, s[4:7], s98 offen offset:1024 sc1 lds
    ds_read_b128 v[88:91], v3 offset:3072
    ds_read_b128 v[92:95], v3 offset:4096
    ds_read_b128 v[96:99], v3 offset:5120
    s_waitcnt lgkmcnt(8)
    v_mfma_f32_32x32x16_bf16 v[44:59], a[8:11], v[116:119], v[44:59]
    ds_read_b128 v[108:111], v0 offset:10240
    ds_read_b128 v[100:103], v3 offset:6144
    ds_read_b128 v[104:107], v3 offset:7168
    v_mfma_f32_32x32x16_bf16 v[44:59], a[12:15], v[120:123], v[44:59]
    ds_read_b128 v[112:115], v0 offset:11264
    buffer_load_dwordx4 v0, s[4:7], s98 offen offset:2048 sc1 lds
    s_waitcnt lgkmcnt(7)
    v_mfma_f32_32x32x16_bf16 v[44:59], a[32:35], v[124:127], v[44:59]
    ds_read_b128 v[116:119], v0 offset:16384
    buffer_load_dwordx4 v0, s[4:7], s98 offen offset:3072 sc1 lds
    v_mfma_f32_32x32x16_bf16 v[44:59], a[36:39], v[128:131], v[44:59]
    ds_read_b128 v[120:123], v0 offset:17408
    s_waitcnt lgkmcnt(2)
    v_mfma_f32_32x32x16_bf16 v[44:59], a[40:43], v[108:111], v[44:59]
    ds_read_b128 v[124:127], v0 offset:18432
    s_add_u32 m0, s97, 36864
    s_add_u32 s98, s98, 4096
    buffer_load_dwordx4 v0, s[4:7], s98 offen offset:0 sc1 lds
    v_mfma_f32_32x32x16_bf16 v[44:59], a[44:47], v[112:115], v[44:59]
    ds_read_b128 v[128:131], v0 offset:19456
    buffer_load_dwordx4 v0, s[4:7], s98 offen offset:1024 sc1 lds
    s_waitcnt lgkmcnt(2)
    v_mfma_f32_32x32x16_bf16 v[44:59], a[64:67], v[116:119], v[44:59]
    ds_read_b128 v[108:111], v0 offset:24576
    v_add_f32 v76, v76, v78
    v_add_f32 v77, v77, v79
    v_add_f32 v78, v80, v82
    v_add_f32 v79, v81, v83
    v_mfma_f32_32x32x16_bf16 v[44:59], a[68:71], v[120:123], v[44:59]
    ds_read_b128 v[112:115], v0 offset:25600
    buffer_load_dwordx4 v0, s[4:7], s98 offen offset:2048 sc1 lds
    v_add_f32 v80, v84, v86
    v_add_f32 v81, v85, v87
    v_add_f32 v82, v88, v90
    v_add_f32 v83, v89, v91
    s_waitcnt lgkmcnt(2)
    v_mfma_f32_32x32x16_bf16 v[44:59], a[72:75], v[124:127], v[44:59]
    ds_read_b128 v[116:119], v0 offset:26624
    buffer_load_dwordx4 v0, s[4:7], s98 offen offset:3072 sc1 lds
    v_add_f32 v84, v92, v94
    v_add_f32 v85, v93, v95
    v_add_f32 v86, v96, v98
    v_add_f32 v87, v97, v99
    v_mfma_f32_32x32x16_bf16 v[44:59], a[76:79], v[128:131], v[44:59]
    ds_read_b128 v[120:123], v0 offset:27648
    v_add_f32 v88, v100, v102
    v_add_f32 v89, v101, v103
    v_add_f32 v90, v104, v106
    v_add_f32 v91, v105, v107
    v_add_f32 v76, v76, v78
    v_add_f32 v77, v77, v79
    s_waitcnt lgkmcnt(2)
    v_mfma_f32_32x32x16_bf16 v[44:59], a[96:99], v[108:111], v[44:59]
    s_waitcnt vmcnt(8)
    s_barrier
    ds_read_b128 v[124:127], v0 offset:4096
    v_add_f32 v78, v80, v82
    v_add_f32 v79, v81, v83
    v_add_f32 v80, v84, v86
    v_add_f32 v81, v85, v87
    v_mfma_f32_32x32x16_bf16 v[44:59], a[100:103], v[112:115], v[44:59]
    ds_read_b128 v[128:131], v0 offset:5120
    v_add_f32 v82, v88, v90
    v_add_f32 v83, v89, v91
    v_add_f32 v76, v76, v78
    v_add_f32 v77, v77, v79
    v_add_f32 v78, v80, v82
    v_add_f32 v79, v81, v83
    s_waitcnt lgkmcnt(2)
    v_mfma_f32_32x32x16_bf16 v[44:59], a[104:107], v[116:119], v[44:59]
    ds_read_b128 v[108:111], v0 offset:6144
    s_cbranch_vccnz L_wqs0
    s_lshl_b32 s91, s22, 14
    s_add_u32 m0, s91, 73728
    s_mov_b32 s90, s74
    buffer_load_dwordx4 v43, s[8:11], s90 offen offset:0 lds
L_wqs0:
    v_mfma_f32_32x32x16_bf16 v[44:59], a[108:111], v[120:123], v[44:59]
    ds_read_b128 v[112:115], v0 offset:7168
    s_cbranch_vccnz L_wqs1
    s_add_u32 s90, s90, 7168
    buffer_load_dwordx4 v43, s[8:11], s90 offen offset:1024 lds
L_wqs1:
    v_add_f32 v76, v76, v78
    v_add_f32 v77, v77, v79
    s_waitcnt lgkmcnt(2)
    v_mfma_f32_32x32x16_bf16 v[44:59], a[16:19], v[124:127], v[44:59]
    ds_read_b128 v[116:119], v0 offset:12288
    v_mul_f32 v76, 0x3b000000, v76
    v_mul_f32 v77, 0x3b000000, v77
    v_fma_f32 v77, -v76, v76, v77
    v_max_f32 v77, 0, v77
    v_mfma_f32_32x32x16_bf16 v[44:59], a[20:23], v[128:131], v[44:59]
    ds_read_b128 v[120:123], v0 offset:13312
    s_cbranch_vccnz L_wqs2
    s_add_u32 s90, s90, 7168
    buffer_load_dwordx4 v43, s[8:11], s90 offen offset:2048 lds
L_wqs2:
    v_add_f32 v77, 0x3727c5ac, v77
    v_rsq_f32 v25, v77
    s_waitcnt lgkmcnt(2)
    v_mfma_f32_32x32x16_bf16 v[44:59], a[24:27], v[108:111], v[44:59]
    ds_read_b128 v[124:127], v0 offset:14336
    s_cbranch_vccnz L_wqs3
    s_add_u32 s90, s90, 7168
    buffer_load_dwordx4 v43, s[8:11], s90 offen offset:3072 lds
L_wqs3:
    v_cvt_pk_bf16_f32 v32, -v76, -v76
    v_mfma_f32_32x32x16_bf16 v[44:59], a[28:31], v[112:115], v[44:59]
    ds_read_b128 v[128:131], v0 offset:15360
    v_mov_b32 v24, v25
    v_mov_b32 v28, v32
    s_nop 0
    v_permlane32_swap_b32 v24, v25
    v_permlane32_swap_b32 v28, v32
    v_cndmask_b32 v26, v24, v25, s[32:33]
    s_waitcnt lgkmcnt(2)
    v_mfma_f32_32x32x16_bf16 v[44:59], a[48:51], v[116:119], v[44:59]
    ds_read_b128 v[108:111], v0 offset:20480
    s_cbranch_vccnz L_wqs4
    s_add_u32 m0, m0, 4096
    s_add_u32 s90, s90, 11264
    buffer_load_dwordx4 v43, s[8:11], s90 offen offset:0 lds
L_wqs4:
    v_mfma_f32_32x32x16_bf16 v[44:59], a[52:55], v[120:123], v[44:59]
    ds_read_b128 v[112:115], v0 offset:21504
    s_cbranch_vccnz L_wqs5
    s_add_u32 s90, s90, 7168
    buffer_load_dwordx4 v43, s[8:11], s90 offen offset:1024 lds
L_wqs5:
    v_mov_b32 v29, v28
    v_mov_b32 v33, v32
    s_waitcnt lgkmcnt(2)
    v_mfma_f32_32x32x16_bf16 v[44:59], a[56:59], v[124:127], v[44:59]
    ds_read_b128 v[116:119], v0 offset:22528
    v_mov_b32 v30, v28
    v_mov_b32 v34, v32
    v_mov_b32 v31, v28
    v_mov_b32 v35, v32
    v_mfma_f32_32x32x16_bf16 v[44:59], a[60:63], v[128:131], v[44:59]
    ds_read_b128 v[120:123], v0 offset:23552
    s_cbranch_vccnz L_wqs6
    s_add_u32 s90, s90, 7168
    buffer_load_dwordx4 v43, s[8:11], s90 offen offset:2048 lds
L_wqs6:
    v_mul_f32 v24, 0xbfb8aa3b, v24
    v_mul_f32 v25, 0xbfb8aa3b, v25
    s_waitcnt lgkmcnt(2)
    v_mfma_f32_32x32x16_bf16 v[44:59], a[80:83], v[108:111], v[44:59]
    ds_read_b128 v[124:127], v0 offset:28672
    s_cbranch_vccnz L_wqs7
    s_add_u32 s90, s90, 7168
    buffer_load_dwordx4 v43, s[8:11], s90 offen offset:3072 lds
L_wqs7:
    v_mfma_f32_32x32x16_bf16 v[44:59], a[84:87], v[112:115], v[44:59]
    ds_read_b128 v[128:131], v0 offset:29696
    s_waitcnt lgkmcnt(2)
    v_mfma_f32_32x32x16_bf16 v[44:59], a[88:91], v[116:119], v[44:59]
    ds_read_b128 v[108:111], v0 offset:30720
    s_cbranch_vccnz L_wqs8
    s_add_u32 m0, m0, 4096
    s_add_u32 s90, s90, 11264
    buffer_load_dwordx4 v43, s[8:11], s90 offen offset:0 lds
L_wqs8:
    v_mfma_f32_32x32x16_bf16 v[44:59], a[92:95], v[120:123], v[44:59]
    ds_read_b128 v[112:115], v0 offset:31744
    s_cbranch_vccnz L_wqs9
    s_add_u32 s90, s90, 7168
    buffer_load_dwordx4 v43, s[8:11], s90 offen offset:1024 lds
L_wqs9:
    s_waitcnt lgkmcnt(2)
    v_mfma_f32_32x32x16_bf16 v[44:59], a[112:115], v[124:127], v[44:59]
    s_waitcnt vmcnt(10)
    s_cbranch_vccz L_xbw
    s_waitcnt vmcnt(0)
L_xbw:
    s_barrier
    ds_read_b128 v[116:119], v0 offset:32768
    v_mfma_f32_32x32x16_bf16 v[44:59], a[116:119], v[128:131], v[44:59]
    ds_read_b128 v[120:123], v0 offset:33792
    s_cbranch_vccnz L_wqs10
    s_add_u32 s90, s90, 7168
    buffer_load_dwordx4 v43, s[8:11], s90 offen offset:2048 lds
L_wqs10:
    s_waitcnt lgkmcnt(2)
    v_mfma_f32_32x32x16_bf16 v[44:59], a[120:123], v[108:111], v[44:59]
    ds_read_b128 v[124:127], v0 offset:34816
    s_cbranch_vccnz L_wqs11
    s_add_u32 s90, s90, 7168
    buffer_load_dwordx4 v43, s[8:11], s90 offen offset:3072 lds
L_wqs11:
    v_mfma_f32_32x32x16_bf16 v[44:59], a[124:127], v[112:115], v[44:59]
    ds_read_b128 v[128:131], v0 offset:35840
    v_mfma_f32_32x32x16_bf16 v[44:59], v[244:247], v[28:31], v[44:59]
    s_cbranch_vccnz L_wqs12
    s_add_u32 m0, m0, 4096
    s_add_u32 s90, s90, 11264
    buffer_load_dwordx4 v43, s[8:11], s90 offen offset:0 lds
L_wqs12:
    s_waitcnt lgkmcnt(2)
    v_mfma_f32_32x32x16_bf16 v[60:75], a[0:3], v[116:119], 0
    ds_read_b128 v[108:111], v0 offset:36864
    s_cbranch_vccnz L_wqs13
    s_add_u32 s90, s90, 7168
    buffer_load_dwordx4 v43, s[8:11], s90 offen offset:1024 lds
L_wqs13:
    v_mfma_f32_32x32x16_bf16 v[60:75], a[4:7], v[120:123], v[60:75]
    ds_read_b128 v[112:115], v0 offset:37888
    s_add_u32 s92, s69, 8192
    buffer_load_dwordx4 a[0:3], v5, s[4:7], s92 offen offset:0 sc1
    s_waitcnt lgkmcnt(2)
    v_mfma_f32_32x32x16_bf16 v[60:75], a[8:11], v[124:127], v[60:75]
    ds_read_b128 v[116:119], v0 offset:38912
    s_cbranch_vccnz L_wqs14
    s_add_u32 s90, s90, 7168
    buffer_load_dwordx4 v43, s[8:11], s90 offen offset:2048 lds
L_wqs14:
    v_mul_f32 v132, v24, v44
    v_mfma_f32_32x32x16_bf16 v[60:75], a[12:15], v[128:131], v[60:75]
    ds_read_b128 v[120:123], v0 offset:39936
    s_cbranch_vccnz L_wqs15
    s_add_u32 s90, s90, 7168
    buffer_load_dwordx4 v43, s[8:11], s90 offen offset:3072 lds
L_wqs15:
    v_mul_f32 v133, v24, v45
    s_add_u32 s93, s70, 8192
    buffer_load_dwordx4 a[4:7], v5, s[4:7], s93 offen offset:0 sc1
    s_waitcnt lgkmcnt(2)
    v_mfma_f32_32x32x16_bf16 v[60:75], a[16:19], v[108:111], v[60:75]
    ds_read_b128 v[124:127], v0 offset:40960
    v_mul_f32 v134, v24, v46
    v_mul_f32 v135, v24, v47
    v_exp_f32 v132, v132
    v_mfma_f32_32x32x16_bf16 v[60:75], a[20:23], v[112:115], v[60:75]
    ds_read_b128 v[128:131], v0 offset:41984
    buffer_load_dwordx4 a[8:11], v5, s[4:7], s92 offen offset:1024 sc1
    v_exp_f32 v133, v133
    v_exp_f32 v134, v134
    s_waitcnt lgkmcnt(2)
    v_mfma_f32_32x32x16_bf16 v[60:75], a[24:27], v[116:119], v[60:75]
    ds_read_b128 v[108:111], v0 offset:43008
    v_exp_f32 v135, v135
    v_add_f32 v132, 1.0, v132
    v_add_f32 v133, 1.0, v133
    v_mfma_f32_32x32x16_bf16 v[60:75], a[28:31], v[120:123], v[60:75]
    ds_read_b128 v[112:115], v0 offset:44032
    buffer_load_dwordx4 a[12:15], v5, s[4:7], s93 offen offset:1024 sc1
    v_add_f32 v134, 1.0, v134
    v_add_f32 v135, 1.0, v135
    v_rcp_f32 v132, v132
    s_waitcnt lgkmcnt(2)
    v_mfma_f32_32x32x16_bf16 v[60:75], a[32:35], v[124:127], v[60:75]
    ds_read_b128 v[116:119], v0 offset:45056
    v_rcp_f32 v133, v133
    v_rcp_f32 v134, v134
    v_mfma_f32_32x32x16_bf16 v[60:75], a[36:39], v[128:131], v[60:75]
    ds_read_b128 v[120:123], v0 offset:46080
    buffer_load_dwordx4 a[16:19], v5, s[4:7], s92 offen offset:2048 sc1
    v_rcp_f32 v135, v135
    v_mul_f32 v132, v132, v44
    v_mul_f32 v133, v133, v45
    s_waitcnt lgkmcnt(2)
    v_mfma_f32_32x32x16_bf16 v[60:75], a[40:43], v[108:111], v[60:75]
    ds_read_b128 v[124:127], v0 offset:47104
    v_mul_f32 v134, v134, v46
    v_mul_f32 v135, v135, v47
    v_cvt_pk_bf16_f32 v44, v132, v133
    v_cvt_pk_bf16_f32 v45, v134, v135
    v_mfma_f32_32x32x16_bf16 v[60:75], a[44:47], v[112:115], v[60:75]
    ds_read_b128 v[128:131], v0 offset:48128
    buffer_load_dwordx4 a[20:23], v5, s[4:7], s93 offen offset:2048 sc1
    v_mul_f32 v136, v24, v48
    v_mul_f32 v137, v24, v49
    v_mul_f32 v138, v24, v50
    v_mul_f32 v139, v24, v51
    s_waitcnt lgkmcnt(2)
    v_mfma_f32_32x32x16_bf16 v[60:75], a[48:51], v[116:119], v[60:75]
    ds_read_b128 v[108:111], v0 offset:49152
    v_exp_f32 v136, v136
    v_exp_f32 v137, v137
    v_mfma_f32_32x32x16_bf16 v[60:75], a[52:55], v[120:123], v[60:75]
    ds_read_b128 v[112:115], v0 offset:50176
    buffer_load_dwordx4 a[24:27], v5, s[4:7], s92 offen offset:3072 sc1
    v_exp_f32 v138, v138
    v_exp_f32 v139, v139
    s_waitcnt lgkmcnt(2)
    v_mfma_f32_32x32x16_bf16 v[60:75], a[56:59], v[124:127], v[60:75]
    ds_read_b128 v[116:119], v0 offset:51200
    v_add_f32 v136, 1.0, v136
    v_add_f32 v137, 1.0, v137
    v_add_f32 v138, 1.0, v138
    v_add_f32 v139, 1.0, v139
    v_mfma_f32_32x32x16_bf16 v[60:75], a[60:63], v[128:131], v[60:75]
    ds_read_b128 v[120:123], v0 offset:52224
    buffer_load_dwordx4 a[28:31], v5, s[4:7], s93 offen offset:3072 sc1
    v_rcp_f32 v136, v136
    v_rcp_f32 v137, v137
    s_waitcnt lgkmcnt(2)
    v_mfma_f32_32x32x16_bf16 v[60:75], a[64:67], v[108:111], v[60:75]
    ds_read_b128 v[124:127], v0 offset:53248
    v_rcp_f32 v138, v138
    v_rcp_f32 v139, v139
    v_mfma_f32_32x32x16_bf16 v[60:75], a[68:71], v[112:115], v[60:75]
    ds_read_b128 v[128:131], v0 offset:54272
    s_add_u32 s92, s69, 16384
    buffer_load_dwordx4 a[32:35], v0, s[4:7], s92 offen offset:0 sc1
    v_mul_f32 v136, v136, v48
    v_mul_f32 v137, v137, v49
    v_mul_f32 v138, v138, v50
    s_waitcnt lgkmcnt(2)
    v_mfma_f32_32x32x16_bf16 v[60:75], a[72:75], v[116:119], v[60:75]
    ds_read_b128 v[108:111], v0 offset:55296
    v_mul_f32 v139, v139, v51
    v_cvt_pk_bf16_f32 v46, v136, v137
    v_cvt_pk_bf16_f32 v47, v138, v139
    v_mul_f32 v140, v24, v52
    v_mfma_f32_32x32x16_bf16 v[60:75], a[76:79], v[120:123], v[60:75]
    ds_read_b128 v[112:115], v0 offset:56320
    s_add_u32 s93, s70, 16384
    buffer_load_dwordx4 a[36:39], v0, s[4:7], s93 offen offset:0 sc1
    v_mul_f32 v141, v24, v53
    v_mul_f32 v142, v24, v54
    v_mul_f32 v143, v24, v55
    s_waitcnt lgkmcnt(2)
    v_mfma_f32_32x32x16_bf16 v[60:75], a[80:83], v[124:127], v[60:75]
    ds_read_b128 v[116:119], v0 offset:57344
    v_exp_f32 v140, v140
    v_exp_f32 v141, v141
    v_mfma_f32_32x32x16_bf16 v[60:75], a[84:87], v[128:131], v[60:75]
    ds_read_b128 v[120:123], v0 offset:58368
    buffer_load_dwordx4 a[40:43], v0, s[4:7], s92 offen offset:1024 sc1
    v_exp_f32 v142, v142
    v_exp_f32 v143, v143
    s_waitcnt lgkmcnt(2)
    v_mfma_f32_32x32x16_bf16 v[60:75], a[88:91], v[108:111], v[60:75]
    ds_read_b128 v[124:127], v0 offset:59392
    v_add_f32 v140, 1.0, v140
    v_add_f32 v141, 1.0, v141
    v_add_f32 v142, 1.0, v142
    v_add_f32 v143, 1.0, v143
    v_mfma_f32_32x32x16_bf16 v[60:75], a[92:95], v[112:115], v[60:75]
    ds_read_b128 v[128:131], v0 offset:60416
    buffer_load_dwordx4 a[44:47], v0, s[4:7], s93 offen offset:1024 sc1
    v_rcp_f32 v140, v140
    v_rcp_f32 v141, v141
    s_waitcnt lgkmcnt(2)
    v_mfma_f32_32x32x16_bf16 v[60:75], a[96:99], v[116:119], v[60:75]
    ds_read_b128 v[108:111], v0 offset:61440
    v_rcp_f32 v142, v142
    v_rcp_f32 v143, v143
    v_mfma_f32_32x32x16_bf16 v[60:75], a[100:103], v[120:123], v[60:75]
    ds_read_b128 v[112:115], v0 offset:62464
    buffer_load_dwordx4 a[48:51], v0, s[4:7], s92 offen offset:2048 sc1
    v_mul_f32 v140, v140, v52
    v_mul_f32 v141, v141, v53
    v_mul_f32 v142, v142, v54
    v_mul_f32 v143, v143, v55
    s_waitcnt lgkmcnt(2)
    v_mfma_f32_32x32x16_bf16 v[60:75], a[104:107], v[124:127], v[60:75]
    ds_read_b128 v[116:119], v0 offset:63488
    v_cvt_pk_bf16_f32 v48, v140, v141
    v_cvt_pk_bf16_f32 v49, v142, v143
    v_mul_f32 v144, v24, v56
    v_mul_f32 v145, v24, v57
    v_mfma_f32_32x32x16_bf16 v[60:75], a[108:111], v[128:131], v[60:75]
    ds_read_b128 v[120:123], v0 offset:64512
    buffer_load_dwordx4 a[52:55], v0, s[4:7], s93 offen offset:2048 sc1
    v_mul_f32 v146, v24, v58
    v_mul_f32 v147, v24, v59
    v_exp_f32 v144, v144
    s_waitcnt lgkmcnt(2)
    v_mfma_f32_32x32x16_bf16 v[60:75], a[112:115], v[108:111], v[60:75]
    ds_read_b128 v[124:127], v0 offset:0
    v_exp_f32 v145, v145
    v_exp_f32 v146, v146
    v_mfma_f32_32x32x16_bf16 v[60:75], a[116:119], v[112:115], v[60:75]
    ds_read_b128 v[128:131], v0 offset:1024
    buffer_load_dwordx4 a[56:59], v0, s[4:7], s92 offen offset:3072 sc1
    v_exp_f32 v147, v147
    v_add_f32 v144, 1.0, v144
    v_add_f32 v145, 1.0, v145
    s_waitcnt lgkmcnt(2)
    v_mfma_f32_32x32x16_bf16 v[60:75], a[120:123], v[116:119], v[60:75]
    ds_read_b128 v[108:111], v0 offset:2048
    v_add_f32 v146, 1.0, v146
    v_add_f32 v147, 1.0, v147
    v_rcp_f32 v144, v144
    v_mfma_f32_32x32x16_bf16 v[60:75], a[124:127], v[120:123], v[60:75]
    ds_read_b128 v[112:115], v0 offset:3072
    buffer_load_dwordx4 a[60:63], v0, s[4:7], s93 offen offset:3072 sc1
    v_rcp_f32 v145, v145
    v_rcp_f32 v146, v146
    v_mfma_f32_32x32x16_bf16 v[60:75], v[244:247], v[32:35], v[60:75]
    v_rcp_f32 v147, v147
    v_mul_f32 v144, v144, v56
    v_mul_f32 v145, v145, v57
    v_mul_f32 v146, v146, v58
    v_mul_f32 v147, v147, v59
    s_waitcnt lgkmcnt(2)
    v_mfma_f32_32x32x16_bf16 v[76:91], a[128:131], v[124:127], 0
    ds_read_b128 v[116:119], v0 offset:4096
    buffer_load_dwordx4 a[64:67], v5, s[4:7], s92 offen offset:0 sc1
    v_cvt_pk_bf16_f32 v50, v144, v145
    v_cvt_pk_bf16_f32 v51, v146, v147
    s_add_u32 s95, s71, 0
    s_cmp_eq_u32 s24, 0
    s_cbranch_scc1 L_slow_22
    buffer_store_dwordx4 v[44:47], v0, s[4:7], s95 offen offset:0
    buffer_store_dwordx4 v[48:51], v0, s[4:7], s95 offen offset:1024
L_join_23:
    v_mfma_f32_32x32x16_bf16 v[76:91], a[132:135], v[128:131], v[76:91]
    ds_read_b128 v[120:123], v0 offset:5120
    s_waitcnt lgkmcnt(2)
    v_mfma_f32_32x32x16_bf16 v[76:91], a[136:139], v[108:111], v[76:91]
    ds_read_b128 v[124:127], v0 offset:6144
    buffer_load_dwordx4 a[68:71], v5, s[4:7], s93 offen offset:0 sc1
    v_mul_f32 v132, v25, v60
    v_mul_f32 v133, v25, v61
    v_mul_f32 v134, v25, v62
    v_mfma_f32_32x32x16_bf16 v[76:91], a[140:143], v[112:115], v[76:91]
    ds_read_b128 v[128:131], v0 offset:7168
    v_mul_f32 v135, v25, v63
    v_exp_f32 v132, v132
    v_exp_f32 v133, v133
    s_waitcnt lgkmcnt(2)
    v_mfma_f32_32x32x16_bf16 v[76:91], a[144:147], v[116:119], v[76:91]
    ds_read_b128 v[108:111], v0 offset:8192
    buffer_load_dwordx4 a[72:75], v5, s[4:7], s92 offen offset:1024 sc1
    v_exp_f32 v134, v134
    v_exp_f32 v135, v135
    v_mfma_f32_32x32x16_bf16 v[76:91], a[148:151], v[120:123], v[76:91]
    ds_read_b128 v[112:115], v0 offset:9216
    v_add_f32 v132, 1.0, v132
    v_add_f32 v133, 1.0, v133
    v_add_f32 v134, 1.0, v134
    v_add_f32 v135, 1.0, v135
    v_rcp_f32 v132, v132
    s_waitcnt lgkmcnt(2)
    v_mfma_f32_32x32x16_bf16 v[76:91], a[152:155], v[124:127], v[76:91]
    ds_read_b128 v[116:119], v0 offset:10240
    buffer_load_dwordx4 a[76:79], v5, s[4:7], s93 offen offset:1024 sc1
    v_rcp_f32 v133, v133
    v_rcp_f32 v134, v134
    v_mfma_f32_32x32x16_bf16 v[76:91], a[156:159], v[128:131], v[76:91]
    ds_read_b128 v[120:123], v0 offset:11264
    v_rcp_f32 v135, v135
    v_mul_f32 v132, v132, v60
    v_mul_f32 v133, v133, v61
    v_mul_f32 v134, v134, v62
    s_waitcnt lgkmcnt(2)
    v_mfma_f32_32x32x16_bf16 v[76:91], a[160:163], v[108:111], v[76:91]
    ds_read_b128 v[124:127], v0 offset:12288
    buffer_load_dwordx4 a[80:83], v5, s[4:7], s92 offen offset:2048 sc1
    v_mul_f32 v135, v135, v63
    v_cvt_pk_bf16_f32 v60, v132, v133
    v_cvt_pk_bf16_f32 v61, v134, v135
    v_mfma_f32_32x32x16_bf16 v[76:91], a[164:167], v[112:115], v[76:91]
    ds_read_b128 v[128:131], v0 offset:13312
    v_mul_f32 v136, v25, v64
    v_mul_f32 v137, v25, v65
    v_mul_f32 v138, v25, v66
    v_mul_f32 v139, v25, v67
    v_exp_f32 v136, v136
    s_waitcnt lgkmcnt(2)
    v_mfma_f32_32x32x16_bf16 v[76:91], a[168:171], v[116:119], v[76:91]
    ds_read_b128 v[108:111], v0 offset:14336
    buffer_load_dwordx4 a[84:87], v5, s[4:7], s93 offen offset:2048 sc1
    v_exp_f32 v137, v137
    v_exp_f32 v138, v138
    v_mfma_f32_32x32x16_bf16 v[76:91], a[172:175], v[120:123], v[76:91]
    ds_read_b128 v[112:115], v0 offset:15360
    v_exp_f32 v139, v139
    v_add_f32 v136, 1.0, v136
    v_add_f32 v137, 1.0, v137
    v_add_f32 v138, 1.0, v138
    s_waitcnt lgkmcnt(2)
    v_mfma_f32_32x32x16_bf16 v[76:91], a[176:179], v[124:127], v[76:91]
    ds_read_b128 v[116:119], v0 offset:16384
    buffer_load_dwordx4 a[88:91], v5, s[4:7], s92 offen offset:3072 sc1
    v_add_f32 v139, 1.0, v139
    v_rcp_f32 v136, v136
    v_mfma_f32_32x32x16_bf16 v[76:91], a[180:183], v[128:131], v[76:91]
    ds_read_b128 v[120:123], v0 offset:17408
    v_rcp_f32 v137, v137
    v_rcp_f32 v138, v138
    v_rcp_f32 v139, v139
    s_waitcnt lgkmcnt(2)
    v_mfma_f32_32x32x16_bf16 v[76:91], a[184:187], v[108:111], v[76:91]
    ds_read_b128 v[124:127], v0 offset:18432
    s_waitcnt vmcnt(6)
    s_cmp_eq_u32 s24, 0
    s_cbranch_scc1 L_slow_24
    s_mov_b64 exec, 1
    buffer_store_dword v36, off, s[4:7], s30 offset:384
    s_mov_b64 exec, -1
L_join_25:
    v_mfma_f32_32x32x16_bf16 v[76:91], a[188:191], v[112:115], v[76:91]
    ds_read_b128 v[128:131], v0 offset:19456
    buffer_load_dwordx4 a[92:95], v5, s[4:7], s93 offen offset:3072 sc1
    v_mul_f32 v136, v136, v64
    v_mul_f32 v137, v137, v65
    v_mul_f32 v138, v138, v66
    v_mul_f32 v139, v139, v67
    s_waitcnt lgkmcnt(2)
    v_mfma_f32_32x32x16_bf16 v[76:91], a[192:195], v[116:119], v[76:91]
    ds_read_b128 v[108:111], v0 offset:20480
    s_add_u32 s92, s69, 24576
    buffer_load_dwordx4 a[96:99], v0, s[4:7], s92 offen offset:0 sc1
    v_cvt_pk_bf16_f32 v62, v136, v137
    v_cvt_pk_bf16_f32 v63, v138, v139
    v_mfma_f32_32x32x16_bf16 v[76:91], a[196:199], v[120:123], v[76:91]
    ds_read_b128 v[112:115], v0 offset:21504
    v_mul_f32 v140, v25, v68
    v_mul_f32 v141, v25, v69
    v_mul_f32 v142, v25, v70
    v_mul_f32 v143, v25, v71
    v_exp_f32 v140, v140
    s_waitcnt lgkmcnt(2)
    v_mfma_f32_32x32x16_bf16 v[76:91], a[200:203], v[124:127], v[76:91]
    ds_read_b128 v[116:119], v0 offset:22528
    s_add_u32 s93, s70, 24576
    buffer_load_dwordx4 a[100:103], v0, s[4:7], s93 offen offset:0 sc1
    v_exp_f32 v141, v141
    v_mfma_f32_32x32x16_bf16 v[76:91], a[204:207], v[128:131], v[76:91]
    ds_read_b128 v[120:123], v0 offset:23552
    v_exp_f32 v142, v142
    v_exp_f32 v143, v143
    v_add_f32 v140, 1.0, v140
    s_waitcnt lgkmcnt(2)
    v_mfma_f32_32x32x16_bf16 v[76:91], a[208:211], v[108:111], v[76:91]
    ds_read_b128 v[124:127], v0 offset:24576
    buffer_load_dwordx4 a[104:107], v0, s[4:7], s92 offen offset:1024 sc1
    v_add_f32 v141, 1.0, v141
    v_add_f32 v142, 1.0, v142
    v_add_f32 v143, 1.0, v143
    v_mfma_f32_32x32x16_bf16 v[76:91], a[212:215], v[112:115], v[76:91]
    ds_read_b128 v[128:131], v0 offset:25600
    v_rcp_f32 v140, v140
    v_rcp_f32 v141, v141
    v_rcp_f32 v142, v142
    s_waitcnt lgkmcnt(2)
    v_mfma_f32_32x32x16_bf16 v[76:91], a[216:219], v[116:119], v[76:91]
    ds_read_b128 v[108:111], v0 offset:26624
    buffer_load_dwordx4 a[108:111], v0, s[4:7], s93 offen offset:1024 sc1
    v_rcp_f32 v143, v143
    v_mul_f32 v140, v140, v68
    v_mfma_f32_32x32x16_bf16 v[76:91], a[220:223], v[120:123], v[76:91]
    ds_read_b128 v[112:115], v0 offset:27648
    v_mul_f32 v141, v141, v69
    v_mul_f32 v142, v142, v70
    v_mul_f32 v143, v143, v71
    v_cvt_pk_bf16_f32 v64, v140, v141
    v_cvt_pk_bf16_f32 v65, v142, v143
    s_waitcnt lgkmcnt(2)
    v_mfma_f32_32x32x16_bf16 v[76:91], a[224:227], v[124:127], v[76:91]
    ds_read_b128 v[116:119], v0 offset:28672
    buffer_load_dword v3, v2, s[4:7], s31 offen offset:384 sc1
    buffer_load_dwordx4 a[112:115], v0, s[4:7], s92 offen offset:2048 sc1
    v_mul_f32 v144, v25, v72
    v_mul_f32 v145, v25, v73
    v_mfma_f32_32x32x16_bf16 v[76:91], a[228:231], v[128:131], v[76:91]
    ds_read_b128 v[120:123], v0 offset:29696
    v_mul_f32 v146, v25, v74
    v_mul_f32 v147, v25, v75
    v_exp_f32 v144, v144
    v_exp_f32 v145, v145
    s_waitcnt lgkmcnt(2)
    v_mfma_f32_32x32x16_bf16 v[76:91], a[232:235], v[108:111], v[76:91]
    ds_read_b128 v[124:127], v0 offset:30720
    buffer_load_dwordx4 a[116:119], v0, s[4:7], s93 offen offset:2048 sc1
    v_exp_f32 v146, v146
    v_exp_f32 v147, v147
    v_mfma_f32_32x32x16_bf16 v[76:91], a[236:239], v[112:115], v[76:91]
    ds_read_b128 v[128:131], v0 offset:31744
    v_add_f32 v144, 1.0, v144
    v_add_f32 v145, 1.0, v145
    v_add_f32 v146, 1.0, v146
    v_add_f32 v147, 1.0, v147
    v_rcp_f32 v144, v144
    s_waitcnt lgkmcnt(2)
    v_mfma_f32_32x32x16_bf16 v[76:91], a[240:243], v[116:119], v[76:91]
    ds_read_b128 v[108:111], v0 offset:32768
    buffer_load_dwordx4 a[120:123], v0, s[4:7], s92 offen offset:3072 sc1
    v_rcp_f32 v145, v145
    v_rcp_f32 v146, v146
    v_mfma_f32_32x32x16_bf16 v[76:91], a[244:247], v[120:123], v[76:91]
    ds_read_b128 v[112:115], v0 offset:33792
    v_rcp_f32 v147, v147
    v_mul_f32 v144, v144, v72
    v_mul_f32 v145, v145, v73
    v_mul_f32 v146, v146, v74
    s_waitcnt lgkmcnt(2)
    v_mfma_f32_32x32x16_bf16 v[76:91], a[248:251], v[124:127], v[76:91]
    ds_read_b128 v[116:119], v0 offset:34816
    buffer_load_dwordx4 a[124:127], v0, s[4:7], s93 offen offset:3072 sc1
    v_mul_f32 v147, v147, v75
    v_cvt_pk_bf16_f32 v66, v144, v145
    v_cvt_pk_bf16_f32 v67, v146, v147
    v_mfma_f32_32x32x16_bf16 v[76:91], a[252:255], v[128:131], v[76:91]
    ds_read_b128 v[120:123], v0 offset:35840
    s_add_u32 s95, s71, 114688
    s_cmp_eq_u32 s24, 0
    s_cbranch_scc1 L_slow_26
    buffer_store_dwordx4 v[60:63], v0, s[4:7], s95 offen offset:0
    buffer_store_dwordx4 v[64:67], v0, s[4:7], s95 offen offset:1024
L_join_27:
    v_mfma_f32_32x32x16_bf16 v[76:91], v[248:251], v[28:31], v[76:91]
    s_waitcnt lgkmcnt(2)
    v_mfma_f32_32x32x16_bf16 v[92:107], a[128:131], v[108:111], 0
    ds_read_b128 v[124:127], v0 offset:36864
    v_mfma_f32_32x32x16_bf16 v[92:107], a[132:135], v[112:115], v[92:107]
    ds_read_b128 v[128:131], v0 offset:37888
    s_waitcnt lgkmcnt(2)
    v_mfma_f32_32x32x16_bf16 v[92:107], a[136:139], v[116:119], v[92:107]
    ds_read_b128 v[108:111], v0 offset:38912
    s_nop 3
    v_mul_f32 v132, v24, v76
    v_mul_f32 v133, v24, v77
    v_mul_f32 v134, v24, v78
    v_mul_f32 v135, v24, v79
    v_mfma_f32_32x32x16_bf16 v[92:107], a[140:143], v[120:123], v[92:107]
    ds_read_b128 v[112:115], v0 offset:39936
    v_exp_f32 v132, v132
    v_exp_f32 v133, v133
    v_exp_f32 v134, v134
    s_waitcnt lgkmcnt(2)
    v_mfma_f32_32x32x16_bf16 v[92:107], a[144:147], v[124:127], v[92:107]
    ds_read_b128 v[116:119], v0 offset:40960
    v_exp_f32 v135, v135
    v_add_f32 v132, 1.0, v132
    v_add_f32 v133, 1.0, v133
    v_mfma_f32_32x32x16_bf16 v[92:107], a[148:151], v[128:131], v[92:107]
    ds_read_b128 v[120:123], v0 offset:41984
    v_add_f32 v134, 1.0, v134
    v_add_f32 v135, 1.0, v135
    v_rcp_f32 v132, v132
    v_rcp_f32 v133, v133
    s_waitcnt lgkmcnt(2)
    v_mfma_f32_32x32x16_bf16 v[92:107], a[152:155], v[108:111], v[92:107]
    ds_read_b128 v[124:127], v0 offset:43008
    v_rcp_f32 v134, v134
    v_rcp_f32 v135, v135
    v_mfma_f32_32x32x16_bf16 v[92:107], a[156:159], v[112:115], v[92:107]
    ds_read_b128 v[128:131], v0 offset:44032
    s_waitcnt vmcnt(6)
    v_xor_b32 v3, s23, v3
    v_cmp_lt_u32 vcc, 7, v3
    s_nop 0
    s_and_b64 vcc, vcc, s[34:35]
    s_cbranch_scc1 L_spin_28
L_back_29:
    s_waitcnt lgkmcnt(2)
    v_mfma_f32_32x32x16_bf16 v[92:107], a[160:163], v[116:119], v[92:107]
    ds_read_b128 v[108:111], v0 offset:45056
    s_add_u32 s94, s73, 0
    buffer_load_dwordx4 a[128:131], v0, s[4:7], s94 offen offset:0 sc1
    v_mul_f32 v132, v132, v76
    v_mul_f32 v133, v133, v77
    v_mfma_f32_32x32x16_bf16 v[92:107], a[164:167], v[120:123], v[92:107]
    ds_read_b128 v[112:115], v0 offset:46080
    v_mul_f32 v134, v134, v78
    v_mul_f32 v135, v135, v79
    v_cvt_pk_bf16_f32 v76, v132, v133
    v_cvt_pk_bf16_f32 v77, v134, v135
    v_mul_f32 v136, v24, v80
    s_waitcnt lgkmcnt(2)
    v_mfma_f32_32x32x16_bf16 v[92:107], a[168:171], v[124:127], v[92:107]
    ds_read_b128 v[116:119], v0 offset:47104
    buffer_load_dwordx4 a[132:135], v0, s[4:7], s94 offen offset:1024 sc1
    v_mul_f32 v137, v24, v81
    v_mul_f32 v138, v24, v82
    v_mul_f32 v139, v24, v83
    v_mfma_f32_32x32x16_bf16 v[92:107], a[172:175], v[128:131], v[92:107]
    ds_read_b128 v[120:123], v0 offset:48128
    v_exp_f32 v136, v136
    v_exp_f32 v137, v137
    v_exp_f32 v138, v138
    s_waitcnt lgkmcnt(2)
    v_mfma_f32_32x32x16_bf16 v[92:107], a[176:179], v[108:111], v[92:107]
    ds_read_b128 v[124:127], v0 offset:49152
    s_waitcnt vmcnt(2)
    s_cmp_eq_u32 s24, 0
    s_cbranch_scc1 L_slow_30
    s_mov_b64 exec, 1
    buffer_store_dword v36, off, s[4:7], s30 offset:512
    s_mov_b64 exec, -1
L_join_31:
    v_mfma_f32_32x32x16_bf16 v[92:107], a[180:183], v[112:115], v[92:107]
    ds_read_b128 v[128:131], v0 offset:50176
    buffer_load_dwordx4 a[136:139], v0, s[4:7], s94 offen offset:2048 sc1
    v_exp_f32 v139, v139
    v_add_f32 v136, 1.0, v136
    v_add_f32 v137, 1.0, v137
    s_waitcnt lgkmcnt(2)
    v_mfma_f32_32x32x16_bf16 v[92:107], a[184:187], v[116:119], v[92:107]
    ds_read_b128 v[108:111], v0 offset:51200
    v_add_f32 v138, 1.0, v138
    v_add_f32 v139, 1.0, v139
    v_rcp_f32 v136, v136
    v_mfma_f32_32x32x16_bf16 v[92:107], a[188:191], v[120:123], v[92:107]
    ds_read_b128 v[112:115], v0 offset:52224
    buffer_load_dwordx4 a[140:143], v0, s[4:7], s94 offen offset:3072 sc1
    v_rcp_f32 v137, v137
    v_rcp_f32 v138, v138
    s_waitcnt lgkmcnt(2)
    v_mfma_f32_32x32x16_bf16 v[92:107], a[192:195], v[124:127], v[92:107]
    ds_read_b128 v[116:119], v0 offset:53248
    v_rcp_f32 v139, v139
    v_mul_f32 v136, v136, v80
    v_mul_f32 v137, v137, v81
    v_mfma_f32_32x32x16_bf16 v[92:107], a[196:199], v[128:131], v[92:107]
    ds_read_b128 v[120:123], v0 offset:54272
    buffer_load_dwordx4 a[144:147], v5, s[4:7], s94 offen offset:0 sc1
    v_mul_f32 v138, v138, v82
    v_mul_f32 v139, v139, v83
    v_cvt_pk_bf16_f32 v78, v136, v137
    v_cvt_pk_bf16_f32 v79, v138, v139
    s_waitcnt lgkmcnt(2)
    v_mfma_f32_32x32x16_bf16 v[92:107], a[200:203], v[108:111], v[92:107]
    ds_read_b128 v[124:127], v0 offset:55296
    v_mul_f32 v140, v24, v84
    v_mul_f32 v141, v24, v85
    v_mul_f32 v142, v24, v86
    v_mul_f32 v143, v24, v87
    v_mfma_f32_32x32x16_bf16 v[92:107], a[204:207], v[112:115], v[92:107]
    ds_read_b128 v[128:131], v0 offset:56320
    buffer_load_dwordx4 a[148:151], v5, s[4:7], s94 offen offset:1024 sc1
    v_exp_f32 v140, v140
    v_exp_f32 v141, v141
    s_waitcnt lgkmcnt(2)
    v_mfma_f32_32x32x16_bf16 v[92:107], a[208:211], v[116:119], v[92:107]
    ds_read_b128 v[108:111], v0 offset:57344
    v_exp_f32 v142, v142
    v_exp_f32 v143, v143
    v_mfma_f32_32x32x16_bf16 v[92:107], a[212:215], v[120:123], v[92:107]
    ds_read_b128 v[112:115], v0 offset:58368
    buffer_load_dwordx4 a[152:155], v5, s[4:7], s94 offen offset:2048 sc1
    v_add_f32 v140, 1.0, v140
    v_add_f32 v141, 1.0, v141
    v_add_f32 v142, 1.0, v142
    v_add_f32 v143, 1.0, v143
    s_waitcnt lgkmcnt(2)
    v_mfma_f32_32x32x16_bf16 v[92:107], a[216:219], v[124:127], v[92:107]
    ds_read_b128 v[116:119], v0 offset:59392
    buffer_load_dword v3, v2, s[4:7], s31 offen offset:512 sc1
    v_rcp_f32 v140, v140
    v_rcp_f32 v141, v141
    v_mfma_f32_32x32x16_bf16 v[92:107], a[220:223], v[128:131], v[92:107]
    ds_read_b128 v[120:123], v0 offset:60416
    buffer_load_dwordx4 a[156:159], v5, s[4:7], s94 offen offset:3072 sc1
    v_rcp_f32 v142, v142
    v_rcp_f32 v143, v143
    s_waitcnt lgkmcnt(2)
    v_mfma_f32_32x32x16_bf16 v[92:107], a[224:227], v[108:111], v[92:107]
    ds_read_b128 v[124:127], v0 offset:61440
    v_mul_f32 v140, v140, v84
    v_mul_f32 v141, v141, v85
    v_mul_f32 v142, v142, v86
    v_mul_f32 v143, v143, v87
    v_mfma_f32_32x32x16_bf16 v[92:107], a[228:231], v[112:115], v[92:107]
    ds_read_b128 v[128:131], v0 offset:62464
    s_add_u32 s94, s73, 8192
    buffer_load_dwordx4 a[160:163], v5, s[4:7], s94 offen offset:2048 sc1
    v_cvt_pk_bf16_f32 v80, v140, v141
    v_cvt_pk_bf16_f32 v81, v142, v143
    v_mul_f32 v144, v24, v88
    s_waitcnt lgkmcnt(2)
    v_mfma_f32_32x32x16_bf16 v[92:107], a[232:235], v[116:119], v[92:107]
    ds_read_b128 v[108:111], v0 offset:63488
    v_mul_f32 v145, v24, v89
    v_mul_f32 v146, v24, v90
    v_mul_f32 v147, v24, v91
    v_exp_f32 v144, v144
    v_mfma_f32_32x32x16_bf16 v[92:107], a[236:239], v[120:123], v[92:107]
    ds_read_b128 v[112:115], v0 offset:64512
    buffer_load_dwordx4 a[164:167], v5, s[4:7], s94 offen offset:3072 sc1
    v_exp_f32 v145, v145
    v_exp_f32 v146, v146
    s_waitcnt lgkmcnt(2)
    v_mfma_f32_32x32x16_bf16 v[92:107], a[240:243], v[124:127], v[92:107]
    v_exp_f32 v147, v147
    v_add_f32 v144, 1.0, v144
    v_add_f32 v145, 1.0, v145
    v_add_f32 v146, 1.0, v146
    v_mfma_f32_32x32x16_bf16 v[92:107], a[244:247], v[128:131], v[92:107]
    s_add_u32 s94, s73, 16384
    buffer_load_dwordx4 a[168:171], v0, s[4:7], s94 offen offset:0 sc1
    v_add_f32 v147, 1.0, v147
    v_rcp_f32 v144, v144
    v_rcp_f32 v145, v145
    s_waitcnt lgkmcnt(0)
    v_mfma_f32_32x32x16_bf16 v[92:107], a[248:251], v[108:111], v[92:107]
    v_rcp_f32 v146, v146
    v_rcp_f32 v147, v147
    v_mul_f32 v144, v144, v88
    v_mfma_f32_32x32x16_bf16 v[92:107], a[252:255], v[112:115], v[92:107]
    buffer_load_dwordx4 a[172:175], v0, s[4:7], s94 offen offset:1024 sc1
    v_mul_f32 v145, v145, v89
    v_mul_f32 v146, v146, v90
    v_mul_f32 v147, v147, v91
    v_cvt_pk_bf16_f32 v82, v144, v145
    v_cvt_pk_bf16_f32 v83, v146, v147
    v_mfma_f32_32x32x16_bf16 v[92:107], v[248:251], v[32:35], v[92:107]
    s_add_u32 s95, s72, 0
    s_cmp_eq_u32 s24, 0
    s_cbranch_scc1 L_slow_32
    buffer_store_dwordx4 v[76:79], v0, s[4:7], s95 offen offset:0
    buffer_store_dwordx4 v[80:83], v0, s[4:7], s95 offen offset:1024
L_join_33:
    s_waitcnt vmcnt(15)
    v_mfma_f32_32x32x16_bf16 v[44:59], v[148:151], a[128:131], 0
    buffer_load_dwordx4 a[176:179], v0, s[4:7], s94 offen offset:2048 sc1
    v_mfma_f32_32x32x16_bf16 v[60:75], v[152:155], a[128:131], 0
    s_waitcnt vmcnt(15)
    v_mfma_f32_32x32x16_bf16 v[44:59], v[156:159], a[132:135], v[44:59]
    buffer_load_dwordx4 a[180:183], v0, s[4:7], s94 offen offset:3072 sc1
    v_mul_f32 v132, v25, v92
    v_mul_f32 v133, v25, v93
    v_mul_f32 v134, v25, v94
    v_mul_f32 v135, v25, v95
    v_mfma_f32_32x32x16_bf16 v[60:75], v[160:163], a[132:135], v[60:75]
    v_exp_f32 v132, v132
    v_exp_f32 v133, v133
    v_exp_f32 v134, v134
    s_waitcnt vmcnt(14)
    v_mfma_f32_32x32x16_bf16 v[44:59], v[164:167], a[136:139], v[44:59]
    buffer_load_dwordx4 a[184:187], v5, s[4:7], s94 offen offset:0 sc1
    v_exp_f32 v135, v135
    v_add_f32 v132, 1.0, v132
    v_add_f32 v133, 1.0, v133
    v_mfma_f32_32x32x16_bf16 v[60:75], v[168:171], a[136:139], v[60:75]
    s_waitcnt vmcnt(10)
    v_xor_b32 v3, s23, v3
    v_cmp_lt_u32 vcc, 7, v3
    s_nop 0
    s_and_b64 vcc, vcc, s[34:35]
    s_cbranch_scc1 L_spin_34
L_back_35:
    v_add_f32 v134, 1.0, v134
    s_waitcnt vmcnt(14)
    v_mfma_f32_32x32x16_bf16 v[44:59], v[172:175], a[140:143], v[44:59]
    buffer_load_dwordx4 a[188:191], v5, s[4:7], s94 offen offset:1024 sc1
    v_add_f32 v135, 1.0, v135
    v_rcp_f32 v132, v132
    v_rcp_f32 v133, v133
    v_mfma_f32_32x32x16_bf16 v[60:75], v[176:179], a[140:143], v[60:75]
    v_rcp_f32 v134, v134
    v_rcp_f32 v135, v135
    v_mul_f32 v132, v132, v92
    v_mul_f32 v133, v133, v93
    s_waitcnt vmcnt(14)
    v_mfma_f32_32x32x16_bf16 v[44:59], v[180:183], a[144:147], v[44:59]
    s_add_u32 s94, s73, 114688
    buffer_load_dwordx4 a[192:195], v0, s[4:7], s94 offen offset:0 sc1
    v_mul_f32 v134, v134, v94
    v_mul_f32 v135, v135, v95
    v_cvt_pk_bf16_f32 v92, v132, v133
    v_mfma_f32_32x32x16_bf16 v[60:75], v[184:187], a[144:147], v[60:75]
    v_cvt_pk_bf16_f32 v93, v134, v135
    v_mul_f32 v136, v25, v96
    v_mul_f32 v137, v25, v97
    v_mul_f32 v138, v25, v98
    v_mul_f32 v139, v25, v99
    v_exp_f32 v136, v136
    s_waitcnt vmcnt(14)
    v_mfma_f32_32x32x16_bf16 v[44:59], v[188:191], a[148:151], v[44:59]
    buffer_load_dwordx4 a[196:199], v0, s[4:7], s94 offen offset:1024 sc1
    v_exp_f32 v137, v137
    v_exp_f32 v138, v138
    v_mfma_f32_32x32x16_bf16 v[60:75], v[192:195], a[148:151], v[60:75]
    v_exp_f32 v139, v139
    v_add_f32 v136, 1.0, v136
    v_add_f32 v137, 1.0, v137
    v_add_f32 v138, 1.0, v138
    v_add_f32 v139, 1.0, v139
    s_waitcnt vmcnt(14)
    v_mfma_f32_32x32x16_bf16 v[44:59], v[196:199], a[152:155], v[44:59]
    buffer_load_dwordx4 a[200:203], v0, s[4:7], s94 offen offset:2048 sc1
    v_rcp_f32 v136, v136
    v_rcp_f32 v137, v137
    v_mfma_f32_32x32x16_bf16 v[60:75], v[200:203], a[152:155], v[60:75]
    s_waitcnt vmcnt(7)
    s_cmp_eq_u32 s24, 0
    s_cbranch_scc1 L_slow_36
    s_mov_b64 exec, 1
    buffer_store_dword v36, off, s[4:7], s30 offset:640
    s_mov_b64 exec, -1
L_join_37:
    s_waitcnt vmcnt(14)
    v_mfma_f32_32x32x16_bf16 v[44:59], v[204:207], a[156:159], v[44:59]
    buffer_load_dwordx4 a[204:207], v0, s[4:7], s94 offen offset:3072 sc1
    v_rcp_f32 v138, v138
    v_rcp_f32 v139, v139
    v_mfma_f32_32x32x16_bf16 v[60:75], v[208:211], a[156:159], v[60:75]
    v_mul_f32 v136, v136, v96
    v_mul_f32 v137, v137, v97
    v_mul_f32 v138, v138, v98
    v_mul_f32 v139, v139, v99
    v_cvt_pk_bf16_f32 v94, v136, v137
    v_cvt_pk_bf16_f32 v95, v138, v139
    s_waitcnt vmcnt(14)
    v_mfma_f32_32x32x16_bf16 v[44:59], a[16:19], a[160:163], v[44:59]
    buffer_load_dwordx4 a[208:211], v5, s[4:7], s94 offen offset:0 sc1
    v_mul_f32 v140, v25, v100
    v_mul_f32 v141, v25, v101
    v_mul_f32 v142, v25, v102
    v_mul_f32 v143, v25, v103
    v_mfma_f32_32x32x16_bf16 v[60:75], a[20:23], a[160:163], v[60:75]
    v_exp_f32 v140, v140
    v_exp_f32 v141, v141
    v_exp_f32 v142, v142
    s_waitcnt vmcnt(14)
    v_mfma_f32_32x32x16_bf16 v[44:59], a[24:27], a[164:167], v[44:59]
    buffer_load_dwordx4 a[212:215], v5, s[4:7], s94 offen offset:1024 sc1
    v_exp_f32 v143, v143
    v_add_f32 v140, 1.0, v140
    v_add_f32 v141, 1.0, v141
    v_mfma_f32_32x32x16_bf16 v[60:75], a[28:31], a[164:167], v[60:75]
    v_add_f32 v142, 1.0, v142
    v_add_f32 v143, 1.0, v143
    v_rcp_f32 v140, v140
    v_rcp_f32 v141, v141
    s_waitcnt vmcnt(14)
    v_mfma_f32_32x32x16_bf16 v[44:59], a[32:35], a[168:171], v[44:59]
    buffer_load_dwordx4 a[216:219], v5, s[4:7], s94 offen offset:2048 sc1
    v_rcp_f32 v142, v142
    v_rcp_f32 v143, v143
    v_mfma_f32_32x32x16_bf16 v[60:75], a[36:39], a[168:171], v[60:75]
    v_mul_f32 v140, v140, v100
    v_mul_f32 v141, v141, v101
    v_mul_f32 v142, v142, v102
    v_mul_f32 v143, v143, v103
    v_cvt_pk_bf16_f32 v96, v140, v141
    v_cvt_pk_bf16_f32 v97, v142, v143
    s_waitcnt vmcnt(14)
    v_mfma_f32_32x32x16_bf16 v[44:59], a[40:43], a[172:175], v[44:59]
    buffer_load_dwordx4 a[220:223], v5, s[4:7], s94 offen offset:3072 sc1
    v_mul_f32 v144, v25, v104
    v_mul_f32 v145, v25, v105
    v_mul_f32 v146, v25, v106
    v_mul_f32 v147, v25, v107
    v_mfma_f32_32x32x16_bf16 v[60:75], a[44:47], a[172:175], v[60:75]
    buffer_load_dword v3, v2, s[4:7], s31 offen offset:640 sc1
    v_exp_f32 v144, v144
    v_exp_f32 v145, v145
    v_exp_f32 v146, v146
    s_waitcnt vmcnt(13)
    v_mfma_f32_32x32x16_bf16 v[44:59], a[48:51], a[176:179], v[44:59]
    s_add_u32 s94, s73, 122880
    buffer_load_dwordx4 a[224:227], v5, s[4:7], s94 offen offset:2048 sc1
    v_exp_f32 v147, v147
    v_add_f32 v144, 1.0, v144
    v_mfma_f32_32x32x16_bf16 v[60:75], a[52:55], a[176:179], v[60:75]
    v_add_f32 v145, 1.0, v145
    v_add_f32 v146, 1.0, v146
    v_add_f32 v147, 1.0, v147
    v_rcp_f32 v144, v144
    v_rcp_f32 v145, v145
    s_waitcnt vmcnt(13)
    v_mfma_f32_32x32x16_bf16 v[44:59], a[56:59], a[180:183], v[44:59]
    buffer_load_dwordx4 a[228:231], v5, s[4:7], s94 offen offset:3072 sc1
    v_rcp_f32 v146, v146
    v_rcp_f32 v147, v147
    v_mfma_f32_32x32x16_bf16 v[60:75], a[60:63], a[180:183], v[60:75]
    v_mul_f32 v144, v144, v104
    v_mul_f32 v145, v145, v105
    v_mul_f32 v146, v146, v106
    v_mul_f32 v147, v147, v107
    v_cvt_pk_bf16_f32 v98, v144, v145
    v_cvt_pk_bf16_f32 v99, v146, v147
    s_waitcnt vmcnt(13)
    v_mfma_f32_32x32x16_bf16 v[44:59], a[64:67], a[184:187], v[44:59]
    s_add_u32 s94, s73, 131072
    buffer_load_dwordx4 a[232:235], v0, s[4:7], s94 offen offset:0 sc1
    s_add_u32 s95, s72, 114688
    s_cmp_eq_u32 s24, 0
    s_cbranch_scc1 L_slow_38
    buffer_store_dwordx4 v[92:95], v0, s[4:7], s95 offen offset:0
    buffer_store_dwordx4 v[96:99], v0, s[4:7], s95 offen offset:1024
L_join_39:
    v_mfma_f32_32x32x16_bf16 v[60:75], a[68:71], a[184:187], v[60:75]
    s_waitcnt vmcnt(15)
    v_mfma_f32_32x32x16_bf16 v[44:59], a[72:75], a[188:191], v[44:59]
    buffer_load_dwordx4 a[236:239], v0, s[4:7], s94 offen offset:1024 sc1
    v_mfma_f32_32x32x16_bf16 v[60:75], a[76:79], a[188:191], v[60:75]
    s_waitcnt vmcnt(15)
    v_mfma_f32_32x32x16_bf16 v[76:91], v[148:151], a[192:195], 0
    buffer_load_dwordx4 a[240:243], v0, s[4:7], s94 offen offset:2048 sc1
    v_mfma_f32_32x32x16_bf16 v[92:107], v[152:155], a[192:195], 0
    s_waitcnt vmcnt(15)
    v_mfma_f32_32x32x16_bf16 v[76:91], v[156:159], a[196:199], v[76:91]
    buffer_load_dwordx4 a[244:247], v0, s[4:7], s94 offen offset:3072 sc1
    v_mfma_f32_32x32x16_bf16 v[92:107], v[160:163], a[196:199], v[92:107]
    s_waitcnt vmcnt(15)
    v_mfma_f32_32x32x16_bf16 v[76:91], v[164:167], a[200:203], v[76:91]
    buffer_load_dwordx4 a[248:251], v5, s[4:7], s94 offen offset:0 sc1
    v_mfma_f32_32x32x16_bf16 v[92:107], v[168:171], a[200:203], v[92:107]
    s_waitcnt vmcnt(14)
    v_mfma_f32_32x32x16_bf16 v[76:91], v[172:175], a[204:207], v[76:91]
    buffer_load_dwordx4 a[252:255], v5, s[4:7], s94 offen offset:1024 sc1
    v_mfma_f32_32x32x16_bf16 v[92:107], v[176:179], a[204:207], v[92:107]
    s_waitcnt vmcnt(10)
    v_xor_b32 v3, s23, v3
    v_cmp_lt_u32 vcc, 7, v3
    s_nop 0
    s_and_b64 vcc, vcc, s[34:35]
    s_cbranch_scc1 L_spin_40
L_back_41:
    s_waitcnt vmcnt(14)
    v_mfma_f32_32x32x16_bf16 v[76:91], v[180:183], a[208:211], v[76:91]
    s_add_u32 s94, s73, 8192
    buffer_load_dwordx4 a[128:131], v0, s[4:7], s94 offen offset:0 sc1
    v_mfma_f32_32x32x16_bf16 v[92:107], v[184:187], a[208:211], v[92:107]
    s_waitcnt vmcnt(14)
    v_mfma_f32_32x32x16_bf16 v[76:91], v[188:191], a[212:215], v[76:91]
    s_waitcnt vmcnt(6)
    s_cmp_eq_u32 s24, 0
    s_cbranch_scc1 L_slow_42
    s_mov_b64 exec, 1
    buffer_store_dword v36, off, s[4:7], s30 offset:768
    s_mov_b64 exec, -1
L_join_43:
    v_mfma_f32_32x32x16_bf16 v[92:107], v[192:195], a[212:215], v[92:107]
    buffer_load_dwordx4 a[132:135], v0, s[4:7], s94 offen offset:1024 sc1
    s_waitcnt vmcnt(15)
    v_mfma_f32_32x32x16_bf16 v[76:91], v[196:199], a[216:219], v[76:91]
    v_mfma_f32_32x32x16_bf16 v[92:107], v[200:203], a[216:219], v[92:107]
    buffer_load_dwordx4 a[136:139], v0, s[4:7], s94 offen offset:2048 sc1
    s_waitcnt vmcnt(15)
    v_mfma_f32_32x32x16_bf16 v[76:91], v[204:207], a[220:223], v[76:91]
    v_mfma_f32_32x32x16_bf16 v[92:107], v[208:211], a[220:223], v[92:107]
    buffer_load_dwordx4 a[140:143], v0, s[4:7], s94 offen offset:3072 sc1
    s_waitcnt vmcnt(14)
    v_mfma_f32_32x32x16_bf16 v[76:91], a[16:19], a[224:227], v[76:91]
    v_mfma_f32_32x32x16_bf16 v[92:107], a[20:23], a[224:227], v[92:107]
    buffer_load_dwordx4 a[144:147], v5, s[4:7], s94 offen offset:0 sc1
    s_waitcnt vmcnt(14)
    v_mfma_f32_32x32x16_bf16 v[76:91], a[24:27], a[228:231], v[76:91]
    v_mfma_f32_32x32x16_bf16 v[92:107], a[28:31], a[228:231], v[92:107]
    buffer_load_dwordx4 a[148:151], v5, s[4:7], s94 offen offset:1024 sc1
    s_waitcnt vmcnt(14)
    v_mfma_f32_32x32x16_bf16 v[76:91], a[32:35], a[232:235], v[76:91]
    buffer_load_dword v3, v2, s[4:7], s31 offen offset:768 sc1
    v_mfma_f32_32x32x16_bf16 v[92:107], a[36:39], a[232:235], v[92:107]
    s_add_u32 s94, s73, 16384
    buffer_load_dwordx4 a[152:155], v5, s[4:7], s94 offen offset:2048 sc1
    s_waitcnt vmcnt(13)
    v_mfma_f32_32x32x16_bf16 v[76:91], a[40:43], a[236:239], v[76:91]
    v_mfma_f32_32x32x16_bf16 v[92:107], a[44:47], a[236:239], v[92:107]
    buffer_load_dwordx4 a[156:159], v5, s[4:7], s94 offen offset:3072 sc1
    s_waitcnt vmcnt(13)
    v_mfma_f32_32x32x16_bf16 v[76:91], a[48:51], a[240:243], v[76:91]
    v_mfma_f32_32x32x16_bf16 v[92:107], a[52:55], a[240:243], v[92:107]
    s_add_u32 s94, s73, 24576
    buffer_load_dwordx4 a[160:163], v0, s[4:7], s94 offen offset:0 sc1
    s_waitcnt vmcnt(13)
    v_mfma_f32_32x32x16_bf16 v[76:91], a[56:59], a[244:247], v[76:91]
    v_mfma_f32_32x32x16_bf16 v[92:107], a[60:63], a[244:247], v[92:107]
    buffer_load_dwordx4 a[164:167], v0, s[4:7], s94 offen offset:1024 sc1
    s_waitcnt vmcnt(13)
    v_mfma_f32_32x32x16_bf16 v[76:91], a[64:67], a[248:251], v[76:91]
    v_mfma_f32_32x32x16_bf16 v[92:107], a[68:71], a[248:251], v[92:107]
    buffer_load_dwordx4 a[168:171], v0, s[4:7], s94 offen offset:2048 sc1
    s_waitcnt vmcnt(13)
    v_mfma_f32_32x32x16_bf16 v[76:91], a[72:75], a[252:255], v[76:91]
    v_mfma_f32_32x32x16_bf16 v[92:107], a[76:79], a[252:255], v[92:107]
    buffer_load_dwordx4 a[172:175], v0, s[4:7], s94 offen offset:3072 sc1
    s_waitcnt vmcnt(13)
    v_mfma_f32_32x32x16_bf16 v[44:59], v[212:215], a[128:131], v[44:59]
    v_mfma_f32_32x32x16_bf16 v[60:75], v[216:219], a[128:131], v[60:75]
    s_waitcnt vmcnt(11)
    v_mfma_f32_32x32x16_bf16 v[44:59], v[220:223], a[132:135], v[44:59]
    v_mfma_f32_32x32x16_bf16 v[60:75], v[224:227], a[132:135], v[60:75]
    s_waitcnt vmcnt(10)
    v_mfma_f32_32x32x16_bf16 v[44:59], v[228:231], a[136:139], v[44:59]
    s_waitcnt vmcnt(6)
    v_xor_b32 v3, s23, v3
    v_cmp_lt_u32 vcc, 7, v3
    s_nop 0
    s_and_b64 vcc, vcc, s[34:35]
    s_cbranch_scc1 L_spin_44
L_back_45:
    v_mfma_f32_32x32x16_bf16 v[60:75], v[232:235], a[136:139], v[60:75]
    s_add_u32 s94, s73, 122880
    buffer_load_dwordx4 a[176:179], v0, s[4:7], s94 offen offset:0 sc1
    s_waitcnt vmcnt(10)
    v_mfma_f32_32x32x16_bf16 v[44:59], v[236:239], a[140:143], v[44:59]
    v_mfma_f32_32x32x16_bf16 v[60:75], v[240:243], a[140:143], v[60:75]
    buffer_load_dwordx4 a[180:183], v0, s[4:7], s94 offen offset:1024 sc1
    s_waitcnt vmcnt(10)
    v_mfma_f32_32x32x16_bf16 v[44:59], a[0:3], a[144:147], v[44:59]
    v_mfma_f32_32x32x16_bf16 v[60:75], a[4:7], a[144:147], v[60:75]
    buffer_load_dwordx4 a[184:187], v0, s[4:7], s94 offen offset:2048 sc1
    s_waitcnt vmcnt(10)
    v_mfma_f32_32x32x16_bf16 v[44:59], a[8:11], a[148:151], v[44:59]
    v_mfma_f32_32x32x16_bf16 v[60:75], a[12:15], a[148:151], v[60:75]
    buffer_load_dwordx4 a[188:191], v0, s[4:7], s94 offen offset:3072 sc1
    s_waitcnt vmcnt(9)
    v_mfma_f32_32x32x16_bf16 v[44:59], a[80:83], a[152:155], v[44:59]
    v_mfma_f32_32x32x16_bf16 v[60:75], a[84:87], a[152:155], v[60:75]
    buffer_load_dwordx4 a[192:195], v5, s[4:7], s94 offen offset:0 sc1
    s_waitcnt vmcnt(9)
    v_mfma_f32_32x32x16_bf16 v[44:59], a[88:91], a[156:159], v[44:59]
    v_mfma_f32_32x32x16_bf16 v[60:75], a[92:95], a[156:159], v[60:75]
    buffer_load_dwordx4 a[196:199], v5, s[4:7], s94 offen offset:1024 sc1
    s_waitcnt vmcnt(9)
    v_mfma_f32_32x32x16_bf16 v[44:59], a[96:99], a[160:163], v[44:59]
    v_mfma_f32_32x32x16_bf16 v[60:75], a[100:103], a[160:163], v[60:75]
    s_add_u32 s94, s73, 131072
    buffer_load_dwordx4 a[200:203], v5, s[4:7], s94 offen offset:2048 sc1
    s_waitcnt vmcnt(9)
    v_mfma_f32_32x32x16_bf16 v[44:59], a[104:107], a[164:167], v[44:59]
    v_mfma_f32_32x32x16_bf16 v[60:75], a[108:111], a[164:167], v[60:75]
    buffer_load_dwordx4 a[204:207], v5, s[4:7], s94 offen offset:3072 sc1
    s_waitcnt vmcnt(9)
    v_mfma_f32_32x32x16_bf16 v[44:59], a[112:115], a[168:171], v[44:59]
    v_mfma_f32_32x32x16_bf16 v[60:75], a[116:119], a[168:171], v[60:75]
    s_add_u32 s94, s73, 139264
    buffer_load_dwordx4 a[208:211], v0, s[4:7], s94 offen offset:0 sc1
    s_waitcnt vmcnt(9)
    v_mfma_f32_32x32x16_bf16 v[44:59], a[120:123], a[172:175], v[44:59]
    v_mfma_f32_32x32x16_bf16 v[60:75], a[124:127], a[172:175], v[60:75]
    buffer_load_dwordx4 a[212:215], v0, s[4:7], s94 offen offset:1024 sc1
    s_waitcnt vmcnt(9)
    v_mfma_f32_32x32x16_bf16 v[76:91], v[212:215], a[176:179], v[76:91]
    v_cndmask_b32 v3, v40, v42, s[32:33]
    v_cndmask_b32 v7, v42, v40, s[32:33]
    s_waitcnt vmcnt(8)
    v_mfma_f32_32x32x16_bf16 v[76:91], v[220:223], a[180:183], v[76:91]
    buffer_load_dwordx4 a[216:219], v0, s[4:7], s94 offen offset:2048 sc1
    s_waitcnt vmcnt(8)
    v_mfma_f32_32x32x16_bf16 v[76:91], v[228:231], a[184:187], v[76:91]
    s_waitcnt vmcnt(7)
    v_mfma_f32_32x32x16_bf16 v[76:91], v[236:239], a[188:191], v[76:91]
    buffer_load_dwordx4 a[220:223], v0, s[4:7], s94 offen offset:3072 sc1
    ds_write_b128 v3, v[44:47] offset:0
    s_waitcnt vmcnt(7)
    v_mfma_f32_32x32x16_bf16 v[76:91], a[0:3], a[192:195], v[76:91]
    s_waitcnt vmcnt(6)
    v_mfma_f32_32x32x16_bf16 v[76:91], a[8:11], a[196:199], v[76:91]
    ds_write_b128 v3, v[48:51] offset:1024
    v_mfma_f32_32x32x16_bf16 v[92:107], v[216:219], a[176:179], v[92:107]
    buffer_load_dword v27, v38, s[4:7], 0 offen sc1
    s_waitcnt vmcnt(6)
    v_mfma_f32_32x32x16_bf16 v[76:91], a[80:83], a[200:203], v[76:91]
    ds_write_b128 v3, v[52:55] offset:2048
    v_mfma_f32_32x32x16_bf16 v[92:107], v[224:227], a[180:183], v[92:107]
    s_waitcnt vmcnt(5)
    v_mfma_f32_32x32x16_bf16 v[76:91], a[88:91], a[204:207], v[76:91]
    ds_write_b128 v3, v[56:59] offset:3072
    v_mfma_f32_32x32x16_bf16 v[92:107], v[232:235], a[184:187], v[92:107]
    s_waitcnt vmcnt(4)
    v_mfma_f32_32x32x16_bf16 v[76:91], a[96:99], a[208:211], v[76:91]
    v_mfma_f32_32x32x16_bf16 v[92:107], v[240:243], a[188:191], v[92:107]
    s_cmp_eq_u32 s27, 0
    s_cbranch_scc1 L_w0_20
    ds_write_b128 v41, v[60:63] offset:0
    ds_write_b128 v41, v[64:67] offset:1024
    ds_write_b128 v41, v[68:71] offset:2048
    ds_write_b128 v41, v[72:75] offset:3072
L_w0_20:
    s_waitcnt vmcnt(3)
    v_mfma_f32_32x32x16_bf16 v[76:91], a[104:107], a[212:215], v[76:91]
    v_mfma_f32_32x32x16_bf16 v[92:107], a[4:7], a[192:195], v[92:107]
    s_waitcnt vmcnt(2)
    v_mfma_f32_32x32x16_bf16 v[76:91], a[112:115], a[216:219], v[76:91]
    v_mfma_f32_32x32x16_bf16 v[92:107], a[12:15], a[196:199], v[92:107]
    s_waitcnt vmcnt(1)
    v_mfma_f32_32x32x16_bf16 v[76:91], a[120:123], a[220:223], v[76:91]
    v_mfma_f32_32x32x16_bf16 v[92:107], a[84:87], a[200:203], v[92:107]
    v_mfma_f32_32x32x16_bf16 v[92:107], a[92:95], a[204:207], v[92:107]
    v_mfma_f32_32x32x16_bf16 v[92:107], a[100:103], a[208:211], v[92:107]
    v_mfma_f32_32x32x16_bf16 v[92:107], a[108:111], a[212:215], v[92:107]
    s_nop 7
    ds_write_b128 v7, v[76:79] offset:0
    ds_write_b128 v7, v[80:83] offset:1024
    v_mfma_f32_32x32x16_bf16 v[92:107], a[116:119], a[216:219], v[92:107]
    ds_write_b128 v7, v[84:87] offset:2048
    ds_write_b128 v7, v[88:91] offset:3072
    v_mfma_f32_32x32x16_bf16 v[92:107], a[124:127], a[220:223], v[92:107]
    s_cmp_lg_u32 s27, 0
    s_cbranch_scc1 L_w1_21
    s_nop 9
    ds_write_b128 v41, v[92:95] offset:0
    ds_write_b128 v41, v[96:99] offset:1024
    ds_write_b128 v41, v[100:103] offset:2048
    ds_write_b128 v41, v[104:107] offset:3072
L_w1_21:
    s_waitcnt lgkmcnt(0)
    s_barrier
    ds_read_b128 v[108:111], v6 offset:0
    ds_read_b128 v[112:115], v6 offset:1024
    ds_read_b128 v[116:119], v6 offset:2048
    ds_read_b128 v[120:123], v6 offset:3072
    ds_read_b128 v[124:127], v6 offset:4096
    ds_read_b128 v[128:131], v6 offset:5120
    ds_read_b128 v[132:135], v6 offset:6144
    ds_read_b128 v[136:139], v6 offset:7168
    ds_read_b128 v[140:143], v6 offset:8192
    ds_read_b128 v[144:147], v6 offset:9216
    ds_read_b128 v[148:151], v6 offset:10240
    ds_read_b128 v[152:155], v6 offset:11264
    v_cndmask_b32 v92, v60, v92, s[32:33]
    v_cndmask_b32 v93, v61, v93, s[32:33]
    v_cndmask_b32 v94, v62, v94, s[32:33]
    v_cndmask_b32 v95, v63, v95, s[32:33]
    v_cndmask_b32 v96, v64, v96, s[32:33]
    v_cndmask_b32 v97, v65, v97, s[32:33]
    v_cndmask_b32 v98, v66, v98, s[32:33]
    v_cndmask_b32 v99, v67, v99, s[32:33]
    v_cndmask_b32 v100, v68, v100, s[32:33]
    v_cndmask_b32 v101, v69, v101, s[32:33]
    v_cndmask_b32 v102, v70, v102, s[32:33]
    v_cndmask_b32 v103, v71, v103, s[32:33]
    v_cndmask_b32 v104, v72, v104, s[32:33]
    v_cndmask_b32 v105, v73, v105, s[32:33]
    v_cndmask_b32 v106, v74, v106, s[32:33]
    v_cndmask_b32 v107, v75, v107, s[32:33]
    s_waitcnt lgkmcnt(8)
    v_pk_add_f32 v[108:109], v[108:109], v[92:93]
    v_pk_add_f32 v[110:111], v[110:111], v[94:95]
    v_pk_add_f32 v[112:113], v[112:113], v[96:97]
    v_pk_add_f32 v[114:115], v[114:115], v[98:99]
    v_pk_add_f32 v[116:117], v[116:117], v[100:101]
    v_pk_add_f32 v[118:119], v[118:119], v[102:103]
    v_pk_add_f32 v[120:121], v[120:121], v[104:105]
    v_pk_add_f32 v[122:123], v[122:123], v[106:107]
    s_waitcnt lgkmcnt(4)
    v_pk_add_f32 v[108:109], v[108:109], v[124:125]
    v_pk_add_f32 v[110:111], v[110:111], v[126:127]
    v_pk_add_f32 v[112:113], v[112:113], v[128:129]
    v_pk_add_f32 v[114:115], v[114:115], v[130:131]
    v_pk_add_f32 v[116:117], v[116:117], v[132:133]
    v_pk_add_f32 v[118:119], v[118:119], v[134:135]
    v_pk_add_f32 v[120:121], v[120:121], v[136:137]
    v_pk_add_f32 v[122:123], v[122:123], v[138:139]
    s_waitcnt lgkmcnt(0)
    v_pk_add_f32 v[108:109], v[108:109], v[140:141]
    v_pk_add_f32 v[110:111], v[110:111], v[142:143]
    v_pk_add_f32 v[112:113], v[112:113], v[144:145]
    v_pk_add_f32 v[114:115], v[114:115], v[146:147]
    v_pk_add_f32 v[116:117], v[116:117], v[148:149]
    v_pk_add_f32 v[118:119], v[118:119], v[150:151]
    v_pk_add_f32 v[120:121], v[120:121], v[152:153]
    v_pk_add_f32 v[122:123], v[122:123], v[154:155]
    v_pk_fma_f32 v[8:9], v[108:109], v[26:27], v[8:9] op_sel_hi:[1,0,1]
    v_pk_fma_f32 v[10:11], v[110:111], v[26:27], v[10:11] op_sel_hi:[1,0,1]
    v_pk_fma_f32 v[12:13], v[112:113], v[26:27], v[12:13] op_sel_hi:[1,0,1]
    v_pk_fma_f32 v[14:15], v[114:115], v[26:27], v[14:15] op_sel_hi:[1,0,1]
    v_pk_fma_f32 v[16:17], v[116:117], v[26:27], v[16:17] op_sel_hi:[1,0,1]
    v_pk_fma_f32 v[18:19], v[118:119], v[26:27], v[18:19] op_sel_hi:[1,0,1]
    v_pk_fma_f32 v[20:21], v[120:121], v[26:27], v[20:21] op_sel_hi:[1,0,1]
    v_pk_fma_f32 v[22:23], v[122:123], v[26:27], v[22:23] op_sel_hi:[1,0,1]
    s_add_u32 s25, s25, 1
    s_add_u32 s31, s31, 896
    s_add_u32 s30, s30, 896
    s_add_u32 s54, s54, 131072
    s_add_u32 s77, s77, 131072
    s_add_u32 s56, s56, 1024
    s_mov_b32 s74, 536870912
    s_cmp_ge_u32 s25, 2
    s_cbranch_scc1 L_final
    v_cvt_pk_bf16_f32 v44, v8, v9
    v_cvt_pk_bf16_f32 v45, v10, v11
    v_cvt_pk_bf16_f32 v46, v12, v13
    v_cvt_pk_bf16_f32 v47, v14, v15
    v_cvt_pk_bf16_f32 v48, v16, v17
    v_cvt_pk_bf16_f32 v49, v18, v19
    v_cvt_pk_bf16_f32 v50, v20, v21
    v_cvt_pk_bf16_f32 v51, v22, v23
    v_permlane32_swap_b32 v44, v46
    v_permlane32_swap_b32 v45, v47
    v_permlane32_swap_b32 v48, v50
    v_permlane32_swap_b32 v49, v51
    s_cmp_eq_u32 s24, 0
    s_cbranch_scc1 L_slow_46
    buffer_store_dwordx4 v[44:47], v0, s[4:7], s49 offen offset:0
    buffer_store_dwordx4 v[48:51], v0, s[4:7], s49 offen offset:1024
    v_dot2_f32_bf16 v52, v44, s29, 0
    v_dot2_f32_bf16 v53, v44, v44, 0
    v_dot2_f32_bf16 v52, v45, s29, v52
    v_dot2_f32_bf16 v53, v45, v45, v53
    v_dot2_f32_bf16 v52, v46, s29, v52
    v_dot2_f32_bf16 v53, v46, v46, v53
    v_dot2_f32_bf16 v52, v47, s29, v52
    v_dot2_f32_bf16 v53, v47, v47, v53
    v_dot2_f32_bf16 v52, v48, s29, v52
    v_dot2_f32_bf16 v53, v48, v48, v53
    v_dot2_f32_bf16 v52, v49, s29, v52
    v_dot2_f32_bf16 v53, v49, v49, v53
    v_dot2_f32_bf16 v52, v50, s29, v52
    v_dot2_f32_bf16 v53, v50, v50, v53
    v_dot2_f32_bf16 v52, v51, s29, v52
    v_dot2_f32_bf16 v53, v51, v51, v53
    s_nop 2
    v_permlane32_swap_b32 v52, v53
    v_add_f32 v52, v52, v53
    buffer_store_dword v52, v4, s[4:7], s50 offen
    s_waitcnt vmcnt(0)
    s_mov_b64 exec, 1
    buffer_store_dword v36, off, s[4:7], s30 offset:0
    s_mov_b64 exec, -1
L_join_47:
    v_xor_b32 v87, 64, v39
    ds_read_b64_tr_b16 v[180:181], v87 offset:0
    ds_read_b64_tr_b16 v[182:183], v87 offset:512
    ds_read_b64_tr_b16 v[184:185], v39 offset:0
    ds_read_b64_tr_b16 v[186:187], v39 offset:512
    ds_read_b64_tr_b16 v[188:189], v87 offset:2048
    ds_read_b64_tr_b16 v[190:191], v87 offset:2560
    ds_read_b64_tr_b16 v[192:193], v39 offset:2048
    ds_read_b64_tr_b16 v[194:195], v39 offset:2560
    s_waitcnt lgkmcnt(6)
    ds_read_b64_tr_b16 v[196:197], v87 offset:4096
    ds_read_b64_tr_b16 v[198:199], v87 offset:4608
    ds_read_b64_tr_b16 v[200:201], v39 offset:4096
    ds_read_b64_tr_b16 v[202:203], v39 offset:4608
    ds_read_b64_tr_b16 v[204:205], v87 offset:6144
    ds_read_b64_tr_b16 v[206:207], v87 offset:6656
    ds_read_b64_tr_b16 v[208:209], v39 offset:6144
    ds_read_b64_tr_b16 v[210:211], v39 offset:6656
    s_waitcnt lgkmcnt(6)
    ds_read_b64_tr_b16 v[212:213], v87 offset:8192
    ds_read_b64_tr_b16 v[214:215], v87 offset:8704
    ds_read_b64_tr_b16 v[216:217], v39 offset:8192
    ds_read_b64_tr_b16 v[218:219], v39 offset:8704
    ds_read_b64_tr_b16 v[220:221], v87 offset:10240
    ds_read_b64_tr_b16 v[222:223], v87 offset:10752
    ds_read_b64_tr_b16 v[224:225], v39 offset:10240
    ds_read_b64_tr_b16 v[226:227], v39 offset:10752
    s_waitcnt lgkmcnt(6)
    buffer_load_dword v3, v2, s[4:7], s31 offen offset:0 sc1
    ds_read_b64_tr_b16 v[228:229], v87 offset:12288
    ds_read_b64_tr_b16 v[230:231], v87 offset:12800
    ds_read_b64_tr_b16 v[232:233], v39 offset:12288
    ds_read_b64_tr_b16 v[234:235], v39 offset:12800
    ds_read_b64_tr_b16 v[236:237], v87 offset:14336
    ds_read_b64_tr_b16 v[238:239], v87 offset:14848
    ds_read_b64_tr_b16 v[240:241], v39 offset:14336
    ds_read_b64_tr_b16 v[242:243], v39 offset:14848
    s_waitcnt lgkmcnt(6)
    v_and_b32 v84, 15, v1
    v_lshrrev_b32 v85, 4, v1
    v_lshlrev_b32 v86, 3, v84
    v_lshl_add_u32 v86, v85, 8, v86
    v_add_u32 v86, 147456, v86
    s_lshl_b32 s97, s22, 12
    v_add_u32 v86, s97, v86
    ds_read_b64_tr_b16 a[0:1], v86 offset:0
    ds_read_b64_tr_b16 a[2:3], v86 offset:128
    ds_read_b64_tr_b16 a[4:5], v86 offset:1024
    ds_read_b64_tr_b16 a[6:7], v86 offset:1152
    ds_read_b64_tr_b16 a[8:9], v86 offset:2048
    ds_read_b64_tr_b16 a[10:11], v86 offset:2176
    ds_read_b64_tr_b16 a[12:13], v86 offset:3072
    ds_read_b64_tr_b16 a[14:15], v86 offset:3200
    s_lshr_b32 s97, s21, 1
    s_and_b32 s97, s97, 1
    s_lshl_b32 s98, s97, 8
    v_lshl_add_u32 v70, v84, 4, s98
    v_lshl_add_u32 v70, v85, 9, v70
    s_and_b32 s98, s52, 4294934527
    s_lshr_b32 s97, s21, 2
    s_lshl_b32 s97, s97, 15
    s_add_u32 s98, s98, s97
    s_add_u32 s99, s98, 4096
    v_lshrrev_b32 v7, 5, v1
    v_lshlrev_b32 v71, 2, v2
    v_lshl_add_u32 v71, v7, 12, v71
    s_waitcnt lgkmcnt(0)
    s_waitcnt vmcnt(0)
    v_xor_b32 v3, s23, v3
    v_cmp_lt_u32 vcc, 7, v3
    s_cbranch_vccnz L_spin_48
L_back_49:
    buffer_load_dwordx4 a[16:19], v70, s[4:7], s98 offen offset:0 sc1
    buffer_load_dwordx4 a[20:23], v70, s[4:7], s98 offen offset:2048 sc1
    buffer_load_dwordx4 a[24:27], v70, s[4:7], s99 offen offset:0 sc1
    buffer_load_dwordx4 a[28:31], v70, s[4:7], s99 offen offset:2048 sc1
    buffer_load_dwordx4 v[172:175], v71, s[4:7], s79 offen offset:0 sc1
    buffer_load_dwordx4 v[176:179], v71, s[4:7], s79 offen offset:1024 sc1
    buffer_load_dwordx4 v[244:247], v71, s[4:7], s79 offen offset:2048 sc1
    buffer_load_dwordx4 v[248:251], v71, s[4:7], s79 offen offset:3072 sc1
    buffer_load_dwordx4 v[108:111], v0, s[4:7], s51 offen offset:0 sc1
    buffer_load_dwordx4 v[112:115], v0, s[4:7], s51 offen offset:1024 sc1
    buffer_load_dwordx4 v[116:119], v0, s[4:7], s51 offen offset:2048 sc1
    buffer_load_dwordx4 v[120:123], v0, s[4:7], s51 offen offset:3072 sc1
    buffer_load_dwordx4 v[124:127], v5, s[4:7], s51 offen offset:0 sc1
    buffer_load_dwordx4 v[128:131], v5, s[4:7], s51 offen offset:1024 sc1
    buffer_load_dwordx4 v[132:135], v5, s[4:7], s51 offen offset:2048 sc1
    buffer_load_dwordx4 v[136:139], v5, s[4:7], s51 offen offset:3072 sc1
    buffer_load_dwordx4 v[140:143], v0, s[4:7], s52 offen offset:0 sc1
    buffer_load_dwordx4 v[144:147], v0, s[4:7], s52 offen offset:1024 sc1
    s_waitcnt vmcnt(14)
    s_lshl_b32 s97, s22, 10
    s_add_u32 s97, s97, 69632
    v_add_u32 v64, s97, v0
    s_bitcmp1_b32 s21, 0
    s_cbranch_scc1 L_kp_50
    v_mfma_f32_16x16x32_bf16 v[60:63], a[0:3], a[16:19], 0
    v_mfma_f32_16x16x32_bf16 v[60:63], a[4:7], a[20:23], v[60:63]
    v_mfma_f32_16x16x32_bf16 v[60:63], a[8:11], a[24:27], v[60:63]
    v_mfma_f32_16x16x32_bf16 v[60:63], a[12:15], a[28:31], v[60:63]
    s_branch L_kq_51
L_kp_50:
    v_mfma_f32_16x16x32_bf16 v[60:63], a[16:19], a[0:3], 0
    v_mfma_f32_16x16x32_bf16 v[60:63], a[20:23], a[4:7], v[60:63]
    v_mfma_f32_16x16x32_bf16 v[60:63], a[24:27], a[8:11], v[60:63]
    v_mfma_f32_16x16x32_bf16 v[60:63], a[28:31], a[12:15], v[60:63]
L_kq_51:
    s_waitcnt vmcnt(10)
    v_pk_add_f32 v[172:173], v[172:173], v[174:175]
    v_pk_add_f32 v[176:177], v[176:177], v[178:179]
    v_pk_add_f32 v[244:245], v[244:245], v[246:247]
    v_pk_add_f32 v[248:249], v[248:249], v[250:251]
    v_pk_add_f32 v[172:173], v[172:173], v[176:177]
    v_pk_add_f32 v[244:245], v[244:245], v[248:249]
    v_pk_add_f32 v[172:173], v[172:173], v[244:245]
    v_mov_b32 v176, v172
    v_mov_b32 v177, v173
    s_nop 0
    v_permlane32_swap_b32 v172, v176
    v_permlane32_swap_b32 v173, v177
    v_pk_add_f32 v[172:173], v[172:173], v[176:177]
    ds_write_b128 v64, v[60:63]
    v_mul_f32 v172, 0x3b000000, v172
    v_mul_f32 v173, 0x3b000000, v173
    v_fma_f32 v173, -v172, v172, v173
    v_max_f32 v173, 0, v173
    v_add_f32 v173, 0x3727c5ac, v173
    v_rsq_f32 v26, v173
    v_cvt_pk_bf16_f32 v28, -v172, -v172
    s_waitcnt lgkmcnt(0)
    s_barrier
    s_cmp_eq_u32 s48, 0
    s_cbranch_scc1 L_kv_nb
    v_add_u32 v64, 69632, v0
    ds_read_b128 v[92:95], v64 offset:0
    ds_read_b128 v[96:99], v64 offset:1024
    ds_read_b128 v[100:103], v64 offset:2048
    ds_read_b128 v[104:107], v64 offset:3072
    v_mov_b32 v64, v84
    v_mov_b32 v65, v85
    v_lshrrev_b32 v66, 1, v65
    v_and_b32 v67, 1, v65
    s_lshr_b32 s97, s21, 1
    s_and_b32 s97, s97, 1
    s_lshl_b32 s98, s97, 6
    v_lshl_add_u32 v68, v64, 2, s98
    v_lshl_add_u32 v69, v65, 4, s98
    ds_bpermute_b32 v72, v68, v28
    ds_bpermute_b32 v76, v68, v26
    ds_bpermute_b32 v80, v69, v26 offset:0
    ds_bpermute_b32 v81, v69, v26 offset:4
    ds_bpermute_b32 v82, v69, v26 offset:8
    ds_bpermute_b32 v83, v69, v26 offset:12
    v_add_u32 v88, 146432, v0
    ds_read_b128 v[88:91], v88
    s_waitcnt lgkmcnt(7)
    v_pk_add_f32 v[92:93], v[92:93], v[96:97]
    v_pk_add_f32 v[100:101], v[100:101], v[104:105]
    v_pk_add_f32 v[94:95], v[94:95], v[98:99]
    v_pk_add_f32 v[102:103], v[102:103], v[106:107]
    v_pk_add_f32 v[84:85], v[92:93], v[100:101]
    v_pk_add_f32 v[86:87], v[94:95], v[102:103]
    s_bitcmp1_b32 s21, 0
    s_cbranch_scc1 L_kv_vb
    s_waitcnt lgkmcnt(0)
    v_mov_b32 v73, v72
    v_mov_b32 v74, v72
    v_mov_b32 v75, v72
    s_nop 1
    v_mfma_f32_16x16x32_bf16 v[84:87], v[88:91], v[72:75], v[84:87]
    s_lshl_b32 s98, s97, 8
    v_lshl_add_u32 v71, v64, 4, s98
    v_lshl_add_u32 v71, v67, 9, v71
    v_lshl_add_u32 v71, v66, 3, v71
    s_nop 3
    v_mul_f32 v84, v76, v84
    v_mul_f32 v85, v76, v85
    v_mul_f32 v86, v76, v86
    v_mul_f32 v87, v76, v87
    s_branch L_kv_stb
L_kv_vb:
    s_nop 1
    s_waitcnt lgkmcnt(0)
    v_mov_b32 v73, v72
    v_mov_b32 v74, v72
    v_mov_b32 v75, v72
    s_nop 1
    v_mfma_f32_16x16x32_bf16 v[84:87], v[72:75], v[88:91], v[84:87]
    s_lshl_b32 s98, s97, 9
    s_add_u32 s98, s98, 4096
    v_lshl_add_u32 v71, v64, 4, s98
    v_lshl_add_u32 v71, v66, 8, v71
    v_lshl_add_u32 v71, v67, 3, v71
    s_nop 2
    v_mul_f32 v84, v80, v84
    v_mul_f32 v85, v81, v85
    v_mul_f32 v86, v82, v86
    v_mul_f32 v87, v83, v87
L_kv_stb:
    v_cvt_pk_bf16_f32 v252, v84, v85
    v_cvt_pk_bf16_f32 v253, v86, v87
    v_mov_b32 v254, v71
    s_add_u32 s98, s77, 262144
    buffer_store_dwordx2 v[252:253], v254, s[4:7], s98 offen
L_kv_nb:
    buffer_load_dwordx4 v[148:151], v0, s[4:7], s52 offen offset:2048 sc1
    buffer_load_dwordx4 v[152:155], v0, s[4:7], s52 offen offset:3072 sc1
    buffer_load_dwordx4 v[156:159], v5, s[4:7], s52 offen offset:0 sc1
    buffer_load_dwordx4 v[160:163], v5, s[4:7], s52 offen offset:1024 sc1
    buffer_load_dwordx4 v[164:167], v5, s[4:7], s52 offen offset:2048 sc1
    buffer_load_dwordx4 v[168:171], v5, s[4:7], s52 offen offset:3072 sc1
    s_nop 1
    s_branch L_layer
L_final:
    v_cvt_pk_bf16_f32 v44, v8, v9
    v_cvt_pk_bf16_f32 v45, v10, v11
    v_cvt_pk_bf16_f32 v46, v12, v13
    v_cvt_pk_bf16_f32 v47, v14, v15
    v_cvt_pk_bf16_f32 v48, v16, v17
    v_cvt_pk_bf16_f32 v49, v18, v19
    v_cvt_pk_bf16_f32 v50, v20, v21
    v_cvt_pk_bf16_f32 v51, v22, v23
    v_permlane32_swap_b32 v44, v46
    v_permlane32_swap_b32 v45, v47
    v_permlane32_swap_b32 v48, v50
    v_permlane32_swap_b32 v49, v51
    s_mov_b32 s16, s42
    s_mov_b32 s17, s43
    s_mov_b32 s18, 2097152
    v_lshrrev_b32 v7, 5, v1
    v_lshlrev_b32 v3, 8, v2
    v_lshl_add_u32 v3, v7, 4, v3
    s_lshl_b32 s97, s27, 15
    s_lshl_b32 s98, s20, 16
    s_add_u32 s97, s97, s98
    s_lshl_b32 s98, s21, 7
    s_add_u32 s97, s97, s98
    s_lshl_b32 s98, s26, 6
    s_add_u32 s97, s97, s98
    buffer_store_dwordx4 v[44:47], v3, s[16:19], s97 offen
    buffer_store_dwordx4 v[48:51], v3, s[16:19], s97 offen offset:32
    s_or_b32 s97, s2, s22
    s_cbranch_scc1 L_ep_done
    s_mov_b32 s97, 0
    s_mov_b64 exec, 1
    buffer_store_dword v36, off, s[4:7], s97 offset:0 sc1
    s_mov_b64 exec, -1
L_ep_done:
L_exit:
    s_endpgm
L_att_retry:
    s_cmp_lg_u32 s38, 0
    s_cbranch_scc1 L_att_ok
    s_mov_b32 s38, 1
    s_waitcnt vmcnt(0)
    v_mov_b32 v177, 0xff800000
    v_mov_b32 v178, 0xff800000
    v_mov_b32 v173, v0
    s_mov_b32 s94, 0
L_mx:
    ds_read_b128 v[148:151], v173
    s_add_u32 s94, s94, 1
    s_and_b32 s95, s94, 3
    s_cmp_eq_u32 s95, 0
    s_cselect_b32 s95, 4096, 0
    s_add_u32 s95, s95, 1024
    s_waitcnt lgkmcnt(0)
    v_mfma_f32_32x32x16_bf16 v[108:123], v[148:151], v[140:143], 0
    v_mfma_f32_32x32x16_bf16 v[124:139], v[148:151], v[144:147], 0
    v_add_u32 v173, s95, v173
    s_nop 9
    v_max3_f32 v177, v177, v108, v109
    v_max3_f32 v177, v177, v110, v111
    v_max3_f32 v177, v177, v112, v113
    v_max3_f32 v177, v177, v114, v115
    v_max3_f32 v177, v177, v116, v117
    v_max3_f32 v177, v177, v118, v119
    v_max3_f32 v177, v177, v120, v121
    v_max3_f32 v177, v177, v122, v123
    v_max3_f32 v178, v178, v124, v125
    v_max3_f32 v178, v178, v126, v127
    v_max3_f32 v178, v178, v128, v129
    v_max3_f32 v178, v178, v130, v131
    v_max3_f32 v178, v178, v132, v133
    v_max3_f32 v178, v178, v134, v135
    v_max3_f32 v178, v178, v136, v137
    v_max3_f32 v178, v178, v138, v139
    s_cmp_lt_u32 s94, 64
    s_cbranch_scc1 L_mx
    v_mov_b32 v173, v0
    v_mov_b32 v174, v176
    ds_read_b128 v[148:151], v173
    ds_read_b128 v[152:155], v173 offset:1024
    ds_read_b128 v[156:159], v174
    ds_read_b128 v[164:167], v174 offset:512
    v_mov_b32 v44, 0
    v_mov_b32 v45, 0
    v_mov_b32 v46, 0
    v_mov_b32 v47, 0
    v_mov_b32 v48, 0
    v_mov_b32 v49, 0
    v_mov_b32 v50, 0
    v_mov_b32 v51, 0
    v_mov_b32 v52, 0
    v_mov_b32 v53, 0
    v_mov_b32 v54, 0
    v_mov_b32 v55, 0
    v_mov_b32 v56, 0
    v_mov_b32 v57, 0
    v_mov_b32 v58, 0
    v_mov_b32 v59, 0
    v_mov_b32 v60, 0
    v_mov_b32 v61, 0
    v_mov_b32 v62, 0
    v_mov_b32 v63, 0
    v_mov_b32 v64, 0
    v_mov_b32 v65, 0
    v_mov_b32 v66, 0
    v_mov_b32 v67, 0
    v_mov_b32 v68, 0
    v_mov_b32 v69, 0
    v_mov_b32 v70, 0
    v_mov_b32 v71, 0
    v_mov_b32 v72, 0
    v_mov_b32 v73, 0
    v_mov_b32 v74, 0
    v_mov_b32 v75, 0
    v_mov_b32 v132, 0
    v_mov_b32 v133, 0
    v_mov_b32 v134, 0
    v_mov_b32 v135, 0
    v_mov_b32 v136, 0
    v_mov_b32 v137, 0
    v_mov_b32 v138, 0
    v_mov_b32 v139, 0
    v_mov_b32 v168, 0
    v_mov_b32 v169, 0
    v_mov_b32 v170, 0
    v_mov_b32 v171, 0
    v_mov_b32 v3, v177
    v_mov_b32 v7, v178
    s_nop 0
    v_permlane32_swap_b32 v3, v177
    v_permlane32_swap_b32 v7, v178
    v_max_f32 v3, v3, v177
    v_max_f32 v7, v7, v178
    v_sub_f32 v76, 0, v3
    v_sub_f32 v77, 0, v3
    v_sub_f32 v78, 0, v3
    v_sub_f32 v79, 0, v3
    v_sub_f32 v80, 0, v3
    v_sub_f32 v81, 0, v3
    v_sub_f32 v82, 0, v3
    v_sub_f32 v83, 0, v3
    v_sub_f32 v84, 0, v3
    v_sub_f32 v85, 0, v3
    v_sub_f32 v86, 0, v3
    v_sub_f32 v87, 0, v3
    v_sub_f32 v88, 0, v3
    v_sub_f32 v89, 0, v3
    v_sub_f32 v90, 0, v3
    v_sub_f32 v91, 0, v3
    s_waitcnt lgkmcnt(0)
    s_nop 0
    v_mfma_f32_32x32x16_bf16 v[108:123], v[148:151], v[140:143], v[76:91]
    v_sub_f32 v92, 0, v7
    v_sub_f32 v93, 0, v7
    v_sub_f32 v94, 0, v7
    v_sub_f32 v95, 0, v7
    v_sub_f32 v96, 0, v7
    v_sub_f32 v97, 0, v7
    v_sub_f32 v98, 0, v7
    v_sub_f32 v99, 0, v7
    v_sub_f32 v100, 0, v7
    v_sub_f32 v101, 0, v7
    v_sub_f32 v102, 0, v7
    v_sub_f32 v103, 0, v7
    v_sub_f32 v104, 0, v7
    v_sub_f32 v105, 0, v7
    v_sub_f32 v106, 0, v7
    v_sub_f32 v107, 0, v7
    s_mov_b32 s94, 0
    s_nop 11
L_rb:
    v_exp_f32 v108, v108
    v_exp_f32 v109, v109
    v_smfmac_f32_32x32x32_bf16 v[60:75], v[168:171], v[132:139], v172
    v_exp_f32 v110, v110
    v_exp_f32 v111, v111
    v_exp_f32 v112, v112
    v_exp_f32 v113, v113
    v_mfma_f32_32x32x16_bf16 v[124:139], v[148:151], v[144:147], v[92:107]
    ds_read_b128 v[148:151], v173 offset:2048
    v_exp_f32 v114, v114
    v_exp_f32 v115, v115
    ds_read_b128 v[160:163], v174 offset:1024
    v_exp_f32 v116, v116
    v_exp_f32 v117, v117
    v_smfmac_f32_32x32x32_bf16 v[44:59], v[156:159], v[108:115], v172
    ds_read_b128 v[168:171], v174 offset:1536
    v_exp_f32 v118, v118
    v_exp_f32 v119, v119
    v_exp_f32 v120, v120
    v_exp_f32 v121, v121
    v_exp_f32 v122, v122
    v_exp_f32 v123, v123
    v_exp_f32 v124, v124
    v_exp_f32 v125, v125
    v_smfmac_f32_32x32x32_bf16 v[44:59], v[164:167], v[116:123], v172
    v_exp_f32 v126, v126
    v_exp_f32 v127, v127
    v_exp_f32 v128, v128
    v_exp_f32 v129, v129
    v_mfma_f32_32x32x16_bf16 v[108:123], v[152:155], v[140:143], v[76:91]
    v_exp_f32 v130, v130
    v_exp_f32 v131, v131
    v_exp_f32 v132, v132
    v_exp_f32 v133, v133
    v_smfmac_f32_32x32x32_bf16 v[60:75], v[156:159], v[124:131], v172
    s_waitcnt lgkmcnt(0)
    v_exp_f32 v134, v134
    v_exp_f32 v135, v135
    v_exp_f32 v136, v136
    v_exp_f32 v137, v137
    v_exp_f32 v138, v138
    v_exp_f32 v139, v139
    v_exp_f32 v108, v108
    v_exp_f32 v109, v109
    v_smfmac_f32_32x32x32_bf16 v[60:75], v[164:167], v[132:139], v172
    v_exp_f32 v110, v110
    v_exp_f32 v111, v111
    v_exp_f32 v112, v112
    v_exp_f32 v113, v113
    v_mfma_f32_32x32x16_bf16 v[124:139], v[152:155], v[144:147], v[92:107]
    ds_read_b128 v[152:155], v173 offset:3072
    v_exp_f32 v114, v114
    v_exp_f32 v115, v115
    ds_read_b128 v[156:159], v174 offset:2048
    v_exp_f32 v116, v116
    v_exp_f32 v117, v117
    v_smfmac_f32_32x32x32_bf16 v[44:59], v[160:163], v[108:115], v172
    ds_read_b128 v[164:167], v174 offset:2560
    v_exp_f32 v118, v118
    v_exp_f32 v119, v119
    v_exp_f32 v120, v120
    v_exp_f32 v121, v121
    v_exp_f32 v122, v122
    v_exp_f32 v123, v123
    v_exp_f32 v124, v124
    v_exp_f32 v125, v125
    v_smfmac_f32_32x32x32_bf16 v[44:59], v[168:171], v[116:123], v172
    v_exp_f32 v126, v126
    v_exp_f32 v127, v127
    v_exp_f32 v128, v128
    v_exp_f32 v129, v129
    v_mfma_f32_32x32x16_bf16 v[108:123], v[148:151], v[140:143], v[76:91]
    v_exp_f32 v130, v130
    v_exp_f32 v131, v131
    v_exp_f32 v132, v132
    v_exp_f32 v133, v133
    v_smfmac_f32_32x32x32_bf16 v[60:75], v[160:163], v[124:131], v172
    s_waitcnt lgkmcnt(0)
    v_exp_f32 v134, v134
    v_exp_f32 v135, v135
    v_exp_f32 v136, v136
    v_exp_f32 v137, v137
    v_exp_f32 v138, v138
    v_exp_f32 v139, v139
    v_exp_f32 v108, v108
    v_exp_f32 v109, v109
    v_smfmac_f32_32x32x32_bf16 v[60:75], v[168:171], v[132:139], v172
    v_exp_f32 v110, v110
    v_exp_f32 v111, v111
    v_exp_f32 v112, v112
    v_exp_f32 v113, v113
    v_mfma_f32_32x32x16_bf16 v[124:139], v[148:151], v[144:147], v[92:107]
    ds_read_b128 v[148:151], v173 offset:8192
    v_exp_f32 v114, v114
    v_exp_f32 v115, v115
    ds_read_b128 v[160:163], v174 offset:3072
    v_exp_f32 v116, v116
    v_exp_f32 v117, v117
    v_smfmac_f32_32x32x32_bf16 v[44:59], v[156:159], v[108:115], v172
    ds_read_b128 v[168:171], v174 offset:3584
    v_exp_f32 v118, v118
    v_exp_f32 v119, v119
    v_exp_f32 v120, v120
    v_exp_f32 v121, v121
    v_exp_f32 v122, v122
    v_exp_f32 v123, v123
    v_exp_f32 v124, v124
    v_exp_f32 v125, v125
    v_smfmac_f32_32x32x32_bf16 v[44:59], v[164:167], v[116:123], v172
    v_exp_f32 v126, v126
    v_exp_f32 v127, v127
    v_exp_f32 v128, v128
    v_exp_f32 v129, v129
    v_mfma_f32_32x32x16_bf16 v[108:123], v[152:155], v[140:143], v[76:91]
    v_exp_f32 v130, v130
    v_exp_f32 v131, v131
    v_exp_f32 v132, v132
    v_exp_f32 v133, v133
    v_smfmac_f32_32x32x32_bf16 v[60:75], v[156:159], v[124:131], v172
    s_waitcnt lgkmcnt(0)
    v_exp_f32 v134, v134
    v_exp_f32 v135, v135
    v_exp_f32 v136, v136
    v_exp_f32 v137, v137
    v_exp_f32 v138, v138
    v_exp_f32 v139, v139
    v_exp_f32 v108, v108
    v_exp_f32 v109, v109
    v_smfmac_f32_32x32x32_bf16 v[60:75], v[164:167], v[132:139], v172
    v_exp_f32 v110, v110
    v_exp_f32 v111, v111
    v_exp_f32 v112, v112
    v_exp_f32 v113, v113
    v_mfma_f32_32x32x16_bf16 v[124:139], v[152:155], v[144:147], v[92:107]
    ds_read_b128 v[152:155], v173 offset:9216
    v_add_u32 v173, 0x2000, v173
    v_add_u32 v174, v175, v174
    v_exp_f32 v114, v114
    v_exp_f32 v115, v115
    ds_read_b128 v[156:159], v174 offset:0
    v_exp_f32 v116, v116
    v_exp_f32 v117, v117
    v_smfmac_f32_32x32x32_bf16 v[44:59], v[160:163], v[108:115], v172
    ds_read_b128 v[164:167], v174 offset:512
    v_exp_f32 v118, v118
    v_exp_f32 v119, v119
    v_exp_f32 v120, v120
    v_exp_f32 v121, v121
    v_exp_f32 v122, v122
    v_exp_f32 v123, v123
    v_exp_f32 v124, v124
    v_exp_f32 v125, v125
    v_smfmac_f32_32x32x32_bf16 v[44:59], v[168:171], v[116:123], v172
    v_exp_f32 v126, v126
    v_exp_f32 v127, v127
    v_exp_f32 v128, v128
    v_exp_f32 v129, v129
    v_mfma_f32_32x32x16_bf16 v[108:123], v[148:151], v[140:143], v[76:91]
    v_exp_f32 v130, v130
    v_exp_f32 v131, v131
    v_exp_f32 v132, v132
    v_exp_f32 v133, v133
    v_smfmac_f32_32x32x32_bf16 v[60:75], v[160:163], v[124:131], v172
    s_waitcnt lgkmcnt(0)
    v_exp_f32 v134, v134
    v_exp_f32 v135, v135
    v_exp_f32 v136, v136
    v_exp_f32 v137, v137
    v_exp_f32 v138, v138
    v_exp_f32 v139, v139
    s_add_u32 s94, s94, 1
    s_cmp_lt_u32 s94, 16
    s_cbranch_scc1 L_rb
    s_nop 15
    s_branch L_att_fin
L_spin_3:
    s_sub_u32 s28, s28, 1
    s_cbranch_scc1 L_exit
    buffer_load_dword v7, v2, s[4:7], s99 offen offset:0 sc1
    s_waitcnt vmcnt(0)
    v_xor_b32 v7, s23, v7
    v_cmp_lt_u32 vcc, 7, v7
    s_cbranch_vccnz L_spin_3
    s_branch L_back_4
L_spin_5:
    s_sub_u32 s28, s28, 1
    s_cbranch_scc1 L_exit
    buffer_load_dwordx4 v[252:255], v0, s[4:7], s56 offen sc1
    s_waitcnt vmcnt(0)
    v_xor_b32 v252, s23, v252
    v_xor_b32 v253, s23, v253
    v_xor_b32 v254, s23, v254
    v_xor_b32 v255, s23, v255
    v_or3_b32 v252, v252, v253, v254
    v_or_b32 v252, v252, v255
    v_cmp_lt_u32 vcc, 7, v252
    s_nop 0
    s_andn2_b64 vcc, vcc, s[92:93]
    s_cbranch_scc1 L_spin_5
    s_branch L_back_6
L_spin_8:
    s_sub_u32 s28, s28, 1
    s_cbranch_scc1 L_exit
    buffer_load_dwordx4 v[252:255], v0, s[4:7], s96 offen sc1
    s_waitcnt vmcnt(0)
    v_xor_b32 v252, s23, v252
    v_xor_b32 v253, s23, v253
    v_xor_b32 v254, s23, v254
    v_xor_b32 v255, s23, v255
    v_or3_b32 v252, v252, v253, v254
    v_or_b32 v252, v252, v255
    v_cmp_lt_u32 vcc, 7, v252
    s_cbranch_vccnz L_spin_8
    s_branch L_back_9
L_slow_10:
    s_nop 15
    buffer_store_dwordx4 v[112:115], v0, s[4:7], s97 offen offset:0 sc1
    buffer_store_dwordx4 v[116:119], v0, s[4:7], s97 offen offset:1024 sc1
    s_branch L_join_11
L_slow_12:
    s_nop 15
    s_mov_b64 exec, 1
    buffer_store_dword v36, off, s[4:7], s30 offset:128 sc1
    s_mov_b64 exec, -1
    s_branch L_join_13
L_spin_14:
    s_sub_u32 s28, s28, 1
    s_cbranch_scc1 L_exit
    buffer_load_dword v3, v2, s[4:7], s31 offen offset:128 sc1
    s_waitcnt vmcnt(0)
    v_xor_b32 v3, s23, v3
    v_cmp_lt_u32 vcc, 7, v3
    s_nop 0
    s_and_b64 vcc, vcc, s[34:35]
    s_cbranch_scc1 L_spin_14
    s_branch L_back_15
L_slow_16:
    s_nop 15
    buffer_store_dwordx4 v[44:47], v0, s[4:7], s49 offen offset:0 sc1
    buffer_store_dwordx4 v[48:51], v0, s[4:7], s49 offen offset:1024 sc1
    v_dot2_f32_bf16 v52, v44, s29, 0
    v_dot2_f32_bf16 v53, v44, v44, 0
    v_dot2_f32_bf16 v52, v45, s29, v52
    v_dot2_f32_bf16 v53, v45, v45, v53
    v_dot2_f32_bf16 v52, v46, s29, v52
    v_dot2_f32_bf16 v53, v46, v46, v53
    v_dot2_f32_bf16 v52, v47, s29, v52
    v_dot2_f32_bf16 v53, v47, v47, v53
    v_dot2_f32_bf16 v52, v48, s29, v52
    v_dot2_f32_bf16 v53, v48, v48, v53
    v_dot2_f32_bf16 v52, v49, s29, v52
    v_dot2_f32_bf16 v53, v49, v49, v53
    v_dot2_f32_bf16 v52, v50, s29, v52
    v_dot2_f32_bf16 v53, v50, v50, v53
    v_dot2_f32_bf16 v52, v51, s29, v52
    v_dot2_f32_bf16 v53, v51, v51, v53
    s_nop 2
    v_permlane32_swap_b32 v52, v53
    v_add_f32 v52, v52, v53
    buffer_store_dword v52, v4, s[4:7], s50 offen sc1
    s_waitcnt vmcnt(0)
    s_mov_b64 exec, 1
    buffer_store_dword v36, off, s[4:7], s30 offset:256 sc1
    s_mov_b64 exec, -1
    s_branch L_join_17
L_spin_18:
    s_sub_u32 s28, s28, 1
    s_cbranch_scc1 L_exit
    buffer_load_dword v3, v2, s[4:7], s31 offen offset:256 sc1
    s_waitcnt vmcnt(0)
    v_xor_b32 v3, s23, v3
    v_cmp_lt_u32 vcc, 7, v3
    s_nop 0
    s_and_b64 vcc, vcc, s[34:35]
    s_cbranch_scc1 L_spin_18
    s_branch L_back_19
L_slow_22:
    s_nop 15
    buffer_store_dwordx4 v[44:47], v0, s[4:7], s95 offen offset:0 sc1
    buffer_store_dwordx4 v[48:51], v0, s[4:7], s95 offen offset:1024 sc1
    s_branch L_join_23
L_slow_24:
    s_nop 15
    s_mov_b64 exec, 1
    buffer_store_dword v36, off, s[4:7], s30 offset:384 sc1
    s_mov_b64 exec, -1
    s_branch L_join_25
L_slow_26:
    s_nop 15
    buffer_store_dwordx4 v[60:63], v0, s[4:7], s95 offen offset:0 sc1
    buffer_store_dwordx4 v[64:67], v0, s[4:7], s95 offen offset:1024 sc1
    s_branch L_join_27
L_spin_28:
    s_sub_u32 s28, s28, 1
    s_cbranch_scc1 L_exit
    buffer_load_dword v3, v2, s[4:7], s31 offen offset:384 sc1
    s_waitcnt vmcnt(0)
    v_xor_b32 v3, s23, v3
    v_cmp_lt_u32 vcc, 7, v3
    s_nop 0
    s_and_b64 vcc, vcc, s[34:35]
    s_cbranch_scc1 L_spin_28
    s_branch L_back_29
L_slow_30:
    s_nop 15
    s_mov_b64 exec, 1
    buffer_store_dword v36, off, s[4:7], s30 offset:512 sc1
    s_mov_b64 exec, -1
    s_branch L_join_31
L_slow_32:
    s_nop 15
    buffer_store_dwordx4 v[76:79], v0, s[4:7], s95 offen offset:0 sc1
    buffer_store_dwordx4 v[80:83], v0, s[4:7], s95 offen offset:1024 sc1
    s_branch L_join_33
L_spin_34:
    s_sub_u32 s28, s28, 1
    s_cbranch_scc1 L_exit
    buffer_load_dword v3, v2, s[4:7], s31 offen offset:512 sc1
    s_waitcnt vmcnt(0)
    v_xor_b32 v3, s23, v3
    v_cmp_lt_u32 vcc, 7, v3
    s_nop 0
    s_and_b64 vcc, vcc, s[34:35]
    s_cbranch_scc1 L_spin_34
    s_branch L_back_35
L_slow_36:
    s_nop 15
    s_mov_b64 exec, 1
    buffer_store_dword v36, off, s[4:7], s30 offset:640 sc1
    s_mov_b64 exec, -1
    s_branch L_join_37
L_slow_38:
    s_nop 15
    buffer_store_dwordx4 v[92:95], v0, s[4:7], s95 offen offset:0 sc1
    buffer_store_dwordx4 v[96:99], v0, s[4:7], s95 offen offset:1024 sc1
    s_branch L_join_39
L_spin_40:
    s_sub_u32 s28, s28, 1
    s_cbranch_scc1 L_exit
    buffer_load_dword v3, v2, s[4:7], s31 offen offset:640 sc1
    s_waitcnt vmcnt(0)
    v_xor_b32 v3, s23, v3
    v_cmp_lt_u32 vcc, 7, v3
    s_nop 0
    s_and_b64 vcc, vcc, s[34:35]
    s_cbranch_scc1 L_spin_40
    s_branch L_back_41
L_slow_42:
    s_nop 15
    s_mov_b64 exec, 1
    buffer_store_dword v36, off, s[4:7], s30 offset:768 sc1
    s_mov_b64 exec, -1
    s_branch L_join_43
L_spin_44:
    s_sub_u32 s28, s28, 1
    s_cbranch_scc1 L_exit
    buffer_load_dword v3, v2, s[4:7], s31 offen offset:768 sc1
    s_waitcnt vmcnt(0)
    v_xor_b32 v3, s23, v3
    v_cmp_lt_u32 vcc, 7, v3
    s_nop 0
    s_and_b64 vcc, vcc, s[34:35]
    s_cbranch_scc1 L_spin_44
    s_branch L_back_45
L_slow_46:
    s_nop 15
    buffer_store_dwordx4 v[44:47], v0, s[4:7], s49 offen offset:0 sc1
    buffer_store_dwordx4 v[48:51], v0, s[4:7], s49 offen offset:1024 sc1
    v_dot2_f32_bf16 v52, v44, s29, 0
    v_dot2_f32_bf16 v53, v44, v44, 0
    v_dot2_f32_bf16 v52, v45, s29, v52
    v_dot2_f32_bf16 v53, v45, v45, v53
    v_dot2_f32_bf16 v52, v46, s29, v52
    v_dot2_f32_bf16 v53, v46, v46, v53
    v_dot2_f32_bf16 v52, v47, s29, v52
    v_dot2_f32_bf16 v53, v47, v47, v53
    v_dot2_f32_bf16 v52, v48, s29, v52
    v_dot2_f32_bf16 v53, v48, v48, v53
    v_dot2_f32_bf16 v52, v49, s29, v52
    v_dot2_f32_bf16 v53, v49, v49, v53
    v_dot2_f32_bf16 v52, v50, s29, v52
    v_dot2_f32_bf16 v53, v50, v50, v53
    v_dot2_f32_bf16 v52, v51, s29, v52
    v_dot2_f32_bf16 v53, v51, v51, v53
    s_nop 2
    v_permlane32_swap_b32 v52, v53
    v_add_f32 v52, v52, v53
    buffer_store_dword v52, v4, s[4:7], s50 offen sc1
    s_waitcnt vmcnt(0)
    s_mov_b64 exec, 1
    buffer_store_dword v36, off, s[4:7], s30 offset:0 sc1
    s_mov_b64 exec, -1
    s_branch L_join_47
L_spin_48:
    s_sub_u32 s28, s28, 1
    s_cbranch_scc1 L_exit
    buffer_load_dword v3, v2, s[4:7], s31 offen offset:0 sc1
    s_waitcnt vmcnt(0)
    v_xor_b32 v3, s23, v3
    v_cmp_lt_u32 vcc, 7, v3
    s_cbranch_vccnz L_spin_48
    s_branch L_back_49
L_end:
    s_endpgm
.section .rodata,"a"
.p2align 6
.amdhsa_kernel interleave_layers__grouped_kv_mqa__dense_activation_silu__prompt_kernel
  .amdhsa_next_free_vgpr 512
  .amdhsa_next_free_sgpr 102
  .amdhsa_accum_offset 256
  .amdhsa_group_segment_fixed_size 0
  .amdhsa_kernarg_size 88
  .amdhsa_user_sgpr_count 2
  .amdhsa_user_sgpr_kernarg_segment_ptr 1
  .amdhsa_system_sgpr_workgroup_id_x 1
.end_amdhsa_kernel
```
